```python
import torch

def _softmax(x, axis=-1):
    return torch.softmax(x, dim=axis)
def _gelu(x):
    return torch.nn.functional.gelu(x, approximate="tanh")
def _silu(x):
    return torch.nn.functional.silu(x)
def _sigmoid(x):
    return torch.sigmoid(x)
def _layernorm(x, axis=-1, eps=1e-5):
    m = x.mean(dim=axis, keepdim=True)
    v = x.var(dim=axis, keepdim=True, unbiased=False)
    return (x - m) / torch.sqrt(v + eps)
def _scatter_add(tgt, idx, src, axis=0):
    return tgt.clone().index_add_(axis, idx, src)
def _segment_sum(src, seg, n):
    out = torch.zeros((n,) + src.shape[1:], dtype=src.dtype)
    return out.index_add_(0, seg, src)
def _pad(x, pw):
    flat = tuple(v for pair in reversed(pw) for v in pair)
    return torch.nn.functional.pad(x, flat)

kernel_name = 'gated_mix__ssm_conv_h3__dense_activation_gelu__prompt'

def setup_inputs():

    _w = (lambda a: (lambda t: t.to(torch.bfloat16) if t.is_floating_point() else t)(torch.as_tensor(a)))
    def _A_setup():
        B, S, D = 1, 2048, 448
        ks = 4
        return {
            "q": _w((lambda *s: torch.randn(*s, dtype=torch.bfloat16) * 0.05)(B, S, D)),
            "k": _w((lambda *s: torch.randn(*s, dtype=torch.bfloat16) * 0.8)(B, S, D)),
            "v": _w((lambda *s: torch.randn(*s, dtype=torch.bfloat16) * 0.8)(B, S, D)),
            "shift_k": _w((lambda *s: torch.randn(*s, dtype=torch.bfloat16) * 0.8)(D, ks) * 0.5),
            "ssm_k": _w((lambda *s: torch.randn(*s, dtype=torch.bfloat16) * 0.8)(D, S) * (1.0 / S ** 0.5)),
            "ssm_D": _w((lambda *s: torch.randn(*s, dtype=torch.bfloat16) * 0.8)(D)),
        }
    _A_in = _A_setup()

    def _B_setup():
        B, S, D, F = 1, 2048, 448, 1792
        return {
            "x": _w((lambda *s: torch.randn(*s, dtype=torch.bfloat16) * 0.05)(B, S, D)),
            "w1": _w((lambda *s: torch.randn(*s, dtype=torch.bfloat16) * 3.2)(D, F) * (D ** -0.5)),
            "b1": _w((lambda *s: torch.randn(*s, dtype=torch.bfloat16) * 3.2)(F) * 0.01),
            "w2": _w((lambda *s: torch.randn(*s, dtype=torch.bfloat16) * 1.6)(F, D) * (F ** -0.5)),
            "b2": _w((lambda *s: torch.randn(*s, dtype=torch.bfloat16) * 3.2)(D) * 0.01),
        }
    _B_in = _B_setup()

    return {
        "A_q": _A_in["q"],
        "A_k": _A_in["k"],
        "A_v": _A_in["v"],
        "A_shift_k": _A_in["shift_k"],
        "A_ssm_k": _A_in["ssm_k"],
        "A_ssm_D": _A_in["ssm_D"],
        "B_x": _B_in["x"],
        "B_w1": _B_in["w1"],
        "B_b1": _B_in["b1"],
        "B_w2": _B_in["w2"],
        "B_b2": _B_in["b2"],
        "gate_w": _w((lambda *s: torch.randn(*s, dtype=torch.bfloat16) * 0.05)(448) * 16.0),
    }

def reference(A_q, A_k, A_v, A_shift_k, A_ssm_k, A_ssm_D, B_x, B_w1, B_b1, B_w2, B_b2, gate_w):
    def _A_ref(q, k, v, shift_k, ssm_k, ssm_D):
        B, S, D = q.shape
        ks = shift_k.shape[-1]
        k_pad = _pad(k, ((0, 0), (ks - 1, 0), (0, 0)))
        k_shift = torch.zeros_like(k)
        for t in range(ks):
            k_shift = k_shift + k_pad[:, t:t + S, :] * shift_k[:, ks - 1 - t][None, None, :]
        kv = k_shift * v
        L = 2 * S
        kv_pad = _pad(kv, ((0, 0), (0, S), (0, 0)))
        kf_pad = _pad(ssm_k, ((0, 0), (0, S)))
        kv_f = (lambda x, axes=(-2,-1): torch.fft.rfft2(x.float(), dim=axes))(kv_pad[:, None, :, :], axes=(1, 2))
        kf_f = (lambda x, axes=(-2,-1): torch.fft.rfft2(x.float(), dim=axes))(kf_pad[:, None, :], axes=(1, 2))
        kf_f = (lambda x, *d: x.permute(*d))(kf_f, 1, 2, 0)
        y_f = kv_f * kf_f[None, :, :, :]
        y = (lambda x, s, axes=(-2,-1): torch.fft.irfft2(x, s=s, dim=axes).to(torch.bfloat16))(y_f, (1, L), axes=(1, 2))[:, 0, :S, :]
        y = y + kv * ssm_D[None, None, :]
        return q * y

    def _B_ref(x, w1, b1, w2, b2):
        h = torch.einsum("bsd,df->bsf", x, w1) + b1
        h = _gelu(h)
        return torch.einsum("bsf,fd->bsd", h, w2) + b2

    x = A_q
    g = _sigmoid((x * gate_w).sum(-1, keepdims=True))
    a = _A_ref(x, A_k, A_v, A_shift_k, A_ssm_k, A_ssm_D)
    b = _B_ref(x, B_w1, B_b1, B_w2, B_b2)
    return g * a + (1 - g) * b
```

```asm
; @launch grid=(256,1,1) block=(256,1,1) lds=163840
.amdgcn_target "amdgcn-amd-amdhsa--gfx950"
.text
.globl gated_mix__ssm_conv_h3__dense_activation_gelu__prompt_kernel
.p2align 12
.p2align 8
.type gated_mix__ssm_conv_h3__dense_activation_gelu__prompt_kernel,@function
gated_mix__ssm_conv_h3__dense_activation_gelu__prompt_kernel:
L_begin:
    s_cmp_ge_u32 s2, 256
    s_cbranch_scc1 L_exit
    s_load_dwordx2 s[8:9], s[0:1], 0
    s_load_dwordx2 s[20:21], s[0:1], 56
    s_load_dwordx2 s[12:13], s[0:1], 8
    s_load_dwordx4 s[40:43], s[0:1], 16
    s_load_dwordx2 s[24:25], s[0:1], 112
    v_lshrrev_b32 v2, 6, v0
    v_and_b32 v1, 63, v0
    s_cmp_ge_u32 s2, 32
    v_readfirstlane_b32 s4, v2
    s_cbranch_scc1 L_main
    s_mov_b32 s14, 0x1c0000
    s_mov_b32 s15, 0x20000
    s_mov_b32 s18, 0x1c0000
    s_mov_b32 s19, 0x20000
    s_mul_i32 s62, s2, 57344
    v_lshrrev_b32 v5, 3, v1
    v_mul_u32_u24 v2, 896, v5
    v_and_b32 v7, 7, v1
    v_lshrrev_b32 v4, 4, v1
    v_xor_b32 v6, v7, v4
    v_lshl_add_u32 v2, v6, 4, v2
    v_add_u32 v2, s62, v2
    s_lshl_b32 s62, s4, 7
    s_sub_u32 s63, s62, 7168
    v_add_u32 v11, s63, v2
    v_mul_u32_u24 v3, 2688, v5
    v_add_u32 v2, v3, v2
    v_xor_b32 v3, 64, v2
    s_mul_i32 s32, s4, 17408
    s_mul_i32 s29, s4, 896
    s_add_u32 s30, s29, 27648
    s_lshl_b32 s28, s4, 11
    v_and_b32 v28, 15, v1
    v_lshl_add_u32 v12, v28, 3, s62
    v_lshl_add_u32 v12, v4, 9, v12
    s_mov_b32 m0, s32
    s_waitcnt lgkmcnt(0)
    s_mov_b32 exec_lo, 0
    buffer_load_dwordx4 v11, s[12:15], 0 offen lds
    s_mov_b32 exec_lo, -1
    s_mov_b64 s[16:17], s[40:41]
    s_load_dword s3, s[24:25], 0
    global_load_dwordx2 v[32:33], v12, s[42:43]
    s_add_u32 m0, s28, 1024
    s_nop 0
    buffer_load_dwordx4 v2, s[12:15], s29 offen offset:0 nt lds
    buffer_load_dwordx4 v3, s[12:15], s30 offen offset:1024 nt lds
    s_add_u32 m0, s28, 9216
    s_nop 0
    buffer_load_dwordx4 v2, s[16:19], s29 offen offset:0 nt lds
    buffer_load_dwordx4 v3, s[16:19], s30 offen offset:1024 nt lds
    s_add_u32 m0, s28, 18304
    s_nop 0
    buffer_load_dwordx4 v2, s[12:15], s29 offen offset:128 nt lds
    buffer_load_dwordx4 v3, s[12:15], s30 offen offset:1152 nt lds
    s_add_u32 m0, s28, 26496
    s_nop 0
    buffer_load_dwordx4 v2, s[16:19], s29 offen offset:128 nt lds
    buffer_load_dwordx4 v3, s[16:19], s30 offen offset:1152 nt lds
    s_branch L_helper2
L_main:
    s_sub_u32 s5, s2, 32
    v_lshrrev_b32 v5, 3, v1
    s_lshr_b32 s63, s5, 3
    v_mul_u32_u24 v2, 896, v5
    s_mul_i32 s65, s63, 37
    v_and_b32 v3, 7, v1
    s_lshr_b32 s65, s65, 8
    v_lshrrev_b32 v4, 4, v1
    s_and_b32 s6, s2, 15
    v_xor_b32 v6, v3, v4
    s_lshl_b32 s6, s6, 2
    s_mov_b32 s60, 0x53423120
    s_mov_b32 s61, 0x20160564
    s_lshr_b64 s[60:61], s[60:61], s6
    v_lshl_add_u32 v2, v6, 4, v2
    s_and_b32 s64, s60, 7
    s_and_b32 s6, s2, 6
    s_lshl1_add_u32 s6, s6, s65
    s_lshl_b32 s62, s64, 7
    s_lshl2_add_u32 s32, s6, s4
    v_add_u32 v2, s62, v2
    s_mul_i32 s32, s32, 28672
    s_lshl_b32 s66, s4, 12
    s_mov_b32 s10, 0x1c0000
    s_mov_b32 s11, 0x20000
    s_mov_b32 m0, s66
    v_xor_b32 v3, 64, v2
    s_add_u32 s33, s32, 6144
    s_waitcnt lgkmcnt(0)
    buffer_load_dwordx4 v2, s[8:11], s32 offen offset:0  lds
    s_lshl_b32 s62, s4, 3
    s_add_u32 s62, s62, 64
    s_load_dwordx2 s[48:49], s[0:1], s62
    s_load_dwordx4 s[44:47], s[0:1], 32
    buffer_load_dwordx4 v3, s[8:11], s33 offen offset:1024  lds
    s_load_dwordx2 s[28:29], s[0:1], 72
    s_load_dwordx2 s[16:17], s[0:1], 96
    s_add_u32 s34, s32, 12288
    s_add_u32 s35, s32, 18432
    v_and_b32 v28, 15, v1
    s_mul_i32 s62, s65, 7
    buffer_load_dwordx4 v2, s[8:11], s34 offen offset:2048  lds
    v_lshlrev_b32 v6, 2, v4
    s_sub_u32 s7, s63, s62
    v_xor_b32 v6, v6, v28
    s_and_b32 s60, s2, 1
    v_mul_u32_u24 v8, 3584, v4
    s_mul_i32 s61, s60, 7
    buffer_load_dwordx4 v3, s[8:11], s35 offen offset:3072  lds
    v_lshl_add_u32 v8, v6, 4, v8
    s_add_u32 s61, s61, s7
    s_mul_i32 s62, s64, 229376
    s_mul_i32 s36, s4, 57344
    v_add_u32 v8, s62, v8
    s_lshl_b32 s67, s61, 8
    s_add_u32 s36, s36, s67
    s_mov_b32 s22, 0x188000
    s_mov_b32 s23, 0x20000
    s_sub_u32 s59, s7, s64
    s_add_u32 s37, s36, 13312
    s_add_u32 s38, s36, 26624
    s_add_u32 s39, s36, 39936
    v_xor_b32 v9, 32, v8
    s_add_u32 m0, s66, 16384
    s_add_u32 s64, s64, 1
    s_cmp_eq_u32 s64, 7
    s_cselect_b32 s100, -6, 1
    s_mul_i32 s101, s100, 229376
    s_lshl_b32 s100, s100, 7
    v_add_u32 v2, s100, v2
    v_add_u32 v3, s100, v3
    buffer_load_dwordx4 v8, s[20:23], s36 offen offset:0 lds
    buffer_load_dwordx4 v8, s[20:23], s37 offen offset:1024 lds
    s_getpc_b64 s[54:55]
L_pcm:
    s_lshl2_add_u32 s62, s63, s4
    s_lshl_b32 s62, s62, 7
    v_mul_u32_u24 v6, 14336, v1
    v_add_u32 v6, s62, v6
    v_min_u32 v6, L_end-L_pcm, v6
    s_mov_b64 exec, 7
    global_load_dword v0, v6, s[54:55]
    s_mov_b64 exec, -1
    s_lshl_b32 s62, s7, 7
    s_cmp_eq_u32 s4, 0
    s_cselect_b32 s62, s67, s62
    s_cselect_b32 s50, 3584, s2
    s_max_u32 s50, s50, 896
    s_mov_b32 s51, 0x20000
    v_lshl_add_u32 v236, v1, 2, s62
    s_lshl_b32 s62, s4, 8
    s_add_u32 m0, s62, 160000
    s_waitcnt lgkmcnt(0)
    buffer_load_dword v236, s[48:51], 0 offen lds
    s_load_dword s3, s[24:25], 0
    s_add_u32 m0, s66, 16384
    s_lshr_b32 s58, s4, 1
    v_add_u32 v8, s101, v8
    buffer_load_dwordx4 v9, s[20:23], s38 offen offset:2048 lds
    buffer_load_dwordx4 v9, s[20:23], s39 offen offset:3072 lds
    v_add_u32 v9, s101, v9
    s_and_b32 s53, s4, 1
    s_add_u32 s62, s59, 7
    s_min_u32 s59, s62, s59
    s_lshl_b32 s67, s65, 1
    s_sub_u32 s63, s67, 5
    s_min_u32 s67, s63, s67
    s_lshl_b32 s62, s5, 1
    s_add_u32 s65, s62, s58
    s_lshl_b32 s63, s65, 12
    s_add_u32 s12, s44, s63
    s_addc_u32 s13, s45, 0
    s_lshl_b32 s62, s5, 2
    s_load_dword s44, s[46:47], s62
    s_mov_b32 s45, s66
    s_mov_b32 s14, 0x1000
    s_mov_b32 s15, 0x20000
    s_mov_b32 s30, 0x188000
    s_mov_b32 s31, 0x20000
    v_lshlrev_b32 v29, 4, v1
    s_lshl_b32 s62, s53, 11
    v_add_u32 v250, s62, v29
    v_add_u32 v251, -8, v250
    s_add_u32 m0, s45, 32768
    s_nop 0
    buffer_load_dwordx4 v2, s[8:11], s32 offen offset:0  lds
    buffer_load_dwordx4 v3, s[8:11], s33 offen offset:1024  lds
    s_mov_b32 s18, 0x1c0000
    s_mov_b32 s19, 0x20000
    s_mov_b32 s26, 0x1100000
    s_mov_b32 s27, 0x20000
    v_mov_b32 v30, 0
    v_bfe_u32 v6, v1, 2, 2
    v_and_b32 v7, 3, v1
    v_bfe_u32 v224, v1, 1, 3
    v_xor_b32 v225, v224, v4
    s_lshl_b32 s62, s53, 13
    s_lshl_b32 s63, s58, 12
    s_add_u32 s62, s62, s63
    v_lshl_add_u32 v226, v28, 7, s62
    v_lshl_add_u32 v10, v225, 4, v226
    v_xor_b32 v11, 0x1000, v10
    v_xor_b32 v12, 64, v10
    v_xor_b32 v13, 64, v11
    v_add_u32 v14, 0x10000, v10
    v_add_u32 v15, 0x10000, v11
    v_add_u32 v16, 0x10000, v12
    v_add_u32 v17, 0x10000, v13
    v_lshrrev_b32 v225, 1, v4
    s_lshl_b32 s62, s60, 2
    v_or_b32 v225, s62, v225
    v_xor_b32 v225, v225, v224
    v_lshl_add_u32 v248, v225, 4, v226
    v_and_b32 v227, 1, v4
    v_lshl_add_u32 v248, v227, 3, v248
    v_lshl_add_u32 v225, v4, 3, v6
    v_lshlrev_b32 v225, 8, v225
    v_lshl_add_u32 v225, v7, 3, v225
    v_lshl_add_u32 v226, v6, 1, v227
    s_lshl_b32 s62, s58, 2
    v_xor_b32 v226, s62, v226
    v_lshl_add_u32 v225, v226, 5, v225
    v_add_u32 v18, 16384, v225
    v_xor_b32 v19, 32, v18
    v_xor_b32 v20, 64, v18
    v_xor_b32 v21, 96, v18
    v_add_u32 v22, 0x10000, v18
    v_add_u32 v23, 0x10000, v19
    v_add_u32 v24, 0x10000, v20
    v_add_u32 v25, 0x10000, v21
    s_lshl_b32 s62, s58, 7
    s_add_u32 s62, s62, 160000
    v_lshl_add_u32 v229, v4, 3, s62
    v_bfe_u32 v232, v1, 4, 2
    v_lshlrev_b32 v232, 4, v232
    v_add_u32 v232, 160768, v232
    s_lshr_b32 s0, s5, 3
    s_bfe_u32 s62, s2, 0x20001
    s_lshl_b32 s63, s60, 2
    s_add_u32 s62, s62, s63
    s_mul_i32 s62, s62, 28
    s_add_u32 s62, s62, s0
    s_lshl_b32 s62, s62, 2
    s_add_u32 s62, s62, s4
    s_mul_i32 s62, s62, 1792
    s_add_u32 s62, s28, s62
    s_addc_u32 s63, s29, 0
    v_mov_b32 v230, s62
    v_mov_b32 v231, s63
    s_lshl_b32 s62, s53, 11
    s_add_u32 s62, s12, s62
    s_addc_u32 s63, s13, 0
    s_mov_b64 exec, 0xffff0000
    v_mov_b32 v230, s62
    v_mov_b32 v231, s63
    s_mov_b64 exec, -1
    v_lshlrev_b32 v225, 7, v28
    v_add_co_u32 v230, vcc, v230, v225
    s_nop 1
    v_addc_co_u32 v231, vcc, 0, v231, vcc
    s_mul_i32 s62, s0, 65
    s_lshr_b32 s62, s62, 8
    s_mul_i32 s62, s62, 4
    s_sub_u32 s0, s0, s62
    s_mov_b32 s54, 0xffff3fff
    s_mov_b32 s55, 0
    v_and_b32 v228, 31, v1
    s_lshl_b32 s62, s5, 10
    s_add_u32 s62, s62, 0xf00100
    v_lshl_add_u32 v234, v228, 2, s62
    s_lshl_b32 s62, s4, 7
    s_sub_u32 s62, s62, 256
    v_add_u32 v233, s62, v234
    v_and_b32 v225, 7, v1
    v_lshlrev_b32 v226, 1, v4
    v_xor_b32 v225, v225, v226
    v_mul_u32_u24 v249, 896, v5
    v_lshl_add_u32 v249, v225, 4, v249
    s_mul_i32 s62, s60, 802816
    s_mul_i32 s63, s4, 28672
    s_add_u32 s62, s62, s63
    s_lshl_b32 s63, s7, 7
    s_add_u32 s62, s62, s63
    v_add_u32 v249, s62, v249
    v_lshl_add_u32 v225, v4, 2, v6
    v_lshlrev_b32 v225, 7, v225
    v_lshl_add_u32 v225, v7, 3, v225
    v_lshrrev_b32 v226, 1, v6
    v_lshl_add_u32 v226, v227, 1, v226
    s_lshl_b32 s62, s60, 1
    v_xor_b32 v226, s62, v226
    v_lshl_add_u32 v225, v226, 5, v225
    s_lshl_b32 s62, s58, 13
    v_add_u32 v225, s62, v225
    v_accvgpr_write_b32 a246, v225
    v_xor_b32 v226, 32, v225
    v_accvgpr_write_b32 a247, v226
    v_xor_b32 v226, 64, v225
    v_accvgpr_write_b32 a244, v226
    v_xor_b32 v226, 96, v225
    v_accvgpr_write_b32 a245, v226
    s_lshl_b32 s62, s7, 1
    s_add_u32 s62, s62, s60
    s_lshl_b32 s62, s62, 4
    s_add_u32 s62, s62, s6
    s_lshl_b32 s62, s62, 10
    s_add_u32 s62, s62, 0xf00000
    v_lshrrev_b32 v226, 5, v1
    v_mul_u32_u24 v226, s4, v226
    v_add_lshl_u32 v225, v226, v1, 2
    v_add_u32 v225, s62, v225
    v_accvgpr_write_b32 a236, v225
    s_add_u32 s63, s62, 128
    s_lshl_b32 s62, s4, 2
    s_add_u32 s63, s63, s62
    s_xor_b32 s63, s63, 0x4000
    v_mov_b32 v225, s63
    v_accvgpr_write_b32 a239, v225
    s_lshl_b32 s62, s6, 2
    s_lshl_b32 s63, s53, 1
    s_add_u32 s62, s62, s63
    s_add_u32 s66, s62, s58
    s_mul_i32 s62, s66, 114688
    s_add_u32 s62, s62, 0x740000
    s_mul_i32 s63, s60, 28672
    s_add_u32 s63, s63, s62
    v_add_u32 v225, s63, v29
    s_lshl_b32 s63, s58, 10
    v_add_u32 v225, s63, v225
    v_accvgpr_write_b32 a229, v225
    v_add_u32 v225, 57344, v225
    v_accvgpr_write_b32 a230, v225
    s_lshl_b32 s63, s61, 12
    s_add_u32 s62, s62, s63
    s_lshl_b32 s63, s58, 10
    s_add_u32 s42, s62, s63
    s_mov_b32 s63, -114688
    s_cmp_eq_u32 s58, 0
    s_cselect_b32 s63, 114688, s63
    s_add_u32 s43, s42, s63
    v_add_u32 v237, 57344, v29
    s_lshl_b32 s62, s6, 1
    s_add_u32 s62, s62, s60
    s_lshl_b32 s63, s62, 1
    s_add_u32 s63, s63, s53
    s_lshl_b32 s63, s63, 1
    s_add_u32 s63, s63, s58
    s_lshl_b32 s63, s63, 10
    s_add_u32 s63, s63, 0xf00180
    v_lshl_add_u32 v225, v228, 2, s63
    v_accvgpr_write_b32 a228, v225
    s_lshl_b32 s48, s7, 2
    s_add_u32 s48, s48, s63
    s_lshl_b32 s62, s62, 2
    s_and_b32 s63, s66, 3
    s_add_u32 s62, s62, s63
    s_mul_i32 s62, s62, 896
    s_add_u32 s56, s62, 0x20000
    s_lshl_b32 s63, s7, 7
    s_add_u32 s40, s56, s63
    v_lshlrev_b32 v225, 3, v28
    v_accvgpr_write_b32 a238, v225
    s_lshl_b32 s62, s60, 6
    s_add_u32 s63, s63, s62
    s_add_u32 s62, s62, 160512
    v_lshl_add_u32 v225, v4, 3, s62
    v_accvgpr_write_b32 a235, v225
    s_mul_i32 s62, s66, 28672
    s_add_u32 s57, s62, s63
    s_lshl_b32 s63, s63, 11
    s_lshl_b32 s62, s66, 6
    s_add_u32 s62, s62, s63
    s_add_u32 s50, s62, 0x200000
    s_add_u32 s51, s50, 64512
    v_lshrrev_b32 v226, 2, v1
    v_lshlrev_b32 v225, 12, v226
    v_lshl_add_u32 v225, v7, 4, v225
    v_accvgpr_write_b32 a237, v225
    v_mul_u32_u24 v225, 896, v226
    v_lshl_add_u32 v225, v7, 4, v225
    v_accvgpr_write_b32 a243, v225
    s_mul_i32 s62, s4, 2560
    s_add_u32 s62, s62, 139264
    v_mul_u32_u24 v225, 80, v226
    v_lshl_add_u32 v225, v7, 4, v225
    v_add_u32 v225, s62, v225
    v_accvgpr_write_b32 a242, v225
    v_mul_u32_u24 v225, 80, v28
    v_lshl_add_u32 v225, v4, 3, v225
    v_add_u32 v225, s62, v225
    v_accvgpr_write_b32 a241, v225
    s_lshl_b32 s62, s4, 11
    s_add_u32 s62, s62, 131072
    v_lshlrev_b32 v225, 6, v226
    v_lshl_add_u32 v225, v7, 3, v225
    v_add_u32 v225, s62, v225
    v_accvgpr_write_b32 a240, v225
    s_mul_i32 s63, s58, 18400
    s_add_u32 s63, s63, 114688
    s_mul_i32 s66, s58, 4224
    buffer_load_dwordx4 v2, s[8:11], s34 offen offset:2048  lds
    buffer_load_dwordx4 v3, s[8:11], s35 offen offset:3072  lds
    s_add_u32 m0, s45, 49152
    s_add_u32 s64, s64, 1
    s_cmp_eq_u32 s64, 7
    s_cselect_b32 s100, -6, 1
    s_mul_i32 s101, s100, 229376
    s_lshl_b32 s100, s100, 7
    v_add_u32 v2, s100, v2
    v_add_u32 v3, s100, v3
    buffer_load_dwordx4 v8, s[20:23], s36 offen offset:0 lds
    buffer_load_dwordx4 v8, s[20:23], s37 offen offset:1024 lds
    v_add_u32 v8, s101, v8
    buffer_load_dwordx4 v9, s[20:23], s38 offen offset:2048 lds
    buffer_load_dwordx4 v9, s[20:23], s39 offen offset:3072 lds
    v_add_u32 v9, s101, v9
    s_mov_b32 exec_hi, 0
    global_atomic_or v233, v30, s[24:25] sc1
    s_mov_b32 exec_hi, -1
    s_mov_b64 exec, 0
    s_cmp_eq_u32 s4, 1
    s_cbranch_scc1 L_stub2
    s_cmp_eq_u32 s4, 2
    s_cbranch_scc1 L_stub4
    s_cmp_eq_u32 s4, 3
    s_cbranch_scc1 L_stub4
    s_branch L_stub0
L_tour_back:
    s_mov_b64 exec, -1
    s_waitcnt lgkmcnt(0)
    s_mul_i32 s3, s3, 1664525
    s_add_u32 s3, s3, 1013904223
    s_max_u32 s3, s3, 1
    v_mov_b32 v31, s3
    s_waitcnt vmcnt(9)
    s_barrier
    ds_read_b64 v[176:177], v229 offset:0
    ds_read_b64 v[178:179], v229 offset:32
    ds_read_b64 v[180:181], v229 offset:64
    ds_read_b64 v[182:183], v229 offset:96
    ds_read_b64_tr_b16 v[96:97], v18 offset:0
    ds_read_b64_tr_b16 v[98:99], v18 offset:1024
    ds_read_b128 v[112:115], v10 offset:0
    ds_read_b128 v[116:119], v10 offset:2048
    ds_read_b128 v[120:123], v11 offset:0
    ds_read_b128 v[124:127], v11 offset:2048
    ds_read_b64_tr_b16 v[100:101], v19 offset:0
    ds_read_b64_tr_b16 v[102:103], v19 offset:1024
    ds_read_b64_tr_b16 v[104:105], v20 offset:0
    ds_read_b64_tr_b16 v[106:107], v20 offset:1024
    ds_read_b64_tr_b16 v[108:109], v21 offset:0
    ds_read_b64_tr_b16 v[110:111], v21 offset:1024
    s_cmp_eq_u32 s0, 0
    s_cselect_b64 exec, s[54:55], 0
    global_load_dword v0, v[230:231], off
    s_mov_b64 exec, -1
    s_add_u32 m0, s45, 65536
    s_nop 0
    buffer_load_dwordx4 v2, s[8:11], s32 offen offset:0  lds
    s_waitcnt lgkmcnt(12)
    v_lshlrev_b32 v160, 16, v176
    v_and_b32 v161, 0xffff0000, v176
    v_lshlrev_b32 v162, 16, v177
    v_and_b32 v163, 0xffff0000, v177
    v_lshlrev_b32 v164, 16, v178
    v_and_b32 v165, 0xffff0000, v178
    v_lshlrev_b32 v166, 16, v179
    v_and_b32 v167, 0xffff0000, v179
    v_lshlrev_b32 v168, 16, v180
    v_and_b32 v169, 0xffff0000, v180
    v_lshlrev_b32 v170, 16, v181
    v_and_b32 v171, 0xffff0000, v181
    v_lshlrev_b32 v172, 16, v182
    v_and_b32 v173, 0xffff0000, v182
    v_lshlrev_b32 v174, 16, v183
    v_and_b32 v175, 0xffff0000, v183
    s_waitcnt lgkmcnt(9)
    v_mfma_f32_16x16x32_bf16 v[32:35], v[96:99], v[112:115], v[160:163]
    s_waitcnt lgkmcnt(8)
    ds_read_b64_tr_b16 v[128:129], v18 offset:8192
    ds_read_b128 v[200:203], v232 offset:0
    v_mfma_f32_16x16x32_bf16 v[40:43], v[96:99], v[116:119], v[160:163]
    s_waitcnt lgkmcnt(9)
    ds_read_b64_tr_b16 v[130:131], v18 offset:9216
    buffer_load_dwordx4 v3, s[8:11], s33 offen offset:1024  lds
    v_mfma_f32_16x16x32_bf16 v[48:51], v[96:99], v[120:123], v[160:163]
    s_waitcnt lgkmcnt(9)
    ds_read_b128 v[144:147], v12 offset:0
    ds_read_b128 v[204:207], v232 offset:64
    v_mfma_f32_16x16x32_bf16 v[56:59], v[96:99], v[124:127], v[160:163]
    s_waitcnt lgkmcnt(9)
    ds_read_b128 v[148:151], v12 offset:2048
    v_mfma_f32_16x16x32_bf16 v[36:39], v[100:103], v[112:115], v[164:167]
    ds_read_b128 v[152:155], v13 offset:0
    v_mfma_f32_16x16x32_bf16 v[44:47], v[100:103], v[116:119], v[164:167]
    ds_read_b128 v[156:159], v13 offset:2048
    buffer_load_dwordx4 v2, s[8:11], s34 offen offset:2048  lds
    v_mfma_f32_16x16x32_bf16 v[52:55], v[100:103], v[120:123], v[164:167]
    ds_read_b64_tr_b16 v[132:133], v19 offset:8192
    v_mfma_f32_16x16x32_bf16 v[60:63], v[100:103], v[124:127], v[164:167]
    s_waitcnt lgkmcnt(11)
    ds_read_b64_tr_b16 v[134:135], v19 offset:9216
    v_mfma_f32_16x16x32_bf16 v[64:67], v[104:107], v[112:115], v[168:171]
    ds_read_b64_tr_b16 v[136:137], v20 offset:8192
    v_mfma_f32_16x16x32_bf16 v[72:75], v[104:107], v[116:119], v[168:171]
    ds_read_b64_tr_b16 v[138:139], v20 offset:9216
    v_mfma_f32_16x16x32_bf16 v[80:83], v[104:107], v[120:123], v[168:171]
    ds_read_b64_tr_b16 v[140:141], v21 offset:8192
    v_mfma_f32_16x16x32_bf16 v[88:91], v[104:107], v[124:127], v[168:171]
    s_waitcnt lgkmcnt(13)
    ds_read_b64_tr_b16 v[142:143], v21 offset:9216
    v_mfma_f32_16x16x32_bf16 v[68:71], v[108:111], v[112:115], v[172:175]
    buffer_load_dwordx4 v3, s[8:11], s35 offen offset:3072  lds
    v_mfma_f32_16x16x32_bf16 v[76:79], v[108:111], v[116:119], v[172:175]
    s_add_u32 m0, s45, 81920
    s_cmp_eq_u32 s59, 0
    s_cbranch_scc1 L_cold_1
L_back_2:
    v_mfma_f32_16x16x32_bf16 v[84:87], v[108:111], v[120:123], v[172:175]
    s_add_u32 s64, s64, 1
    s_cmp_eq_u32 s64, 7
    s_cselect_b32 s100, -6, 1
    s_mul_i32 s101, s100, 229376
    s_lshl_b32 s100, s100, 7
    v_add_u32 v2, s100, v2
    v_add_u32 v3, s100, v3
    buffer_load_dwordx4 v8, s[20:23], s36 offen offset:0 lds
    v_mfma_f32_16x16x32_bf16 v[92:95], v[108:111], v[124:127], v[172:175]
    s_waitcnt lgkmcnt(10)
    v_mfma_f32_16x16x32_bf16 v[32:35], v[128:131], v[144:147], v[32:35]
    s_waitcnt lgkmcnt(8)
    v_mfma_f32_16x16x32_bf16 v[40:43], v[128:131], v[148:151], v[40:43]
    s_waitcnt lgkmcnt(7)
    v_mfma_f32_16x16x32_bf16 v[48:51], v[128:131], v[152:155], v[48:51]
    s_waitcnt lgkmcnt(6)
    s_add_u32 s66, s66, 151552
    v_add_u32 v238, s63, v250
    s_lshl_b32 s62, s53, 11
    s_add_u32 s47, s66, s62
    s_sub_u32 s62, s66, s62
    s_add_u32 s62, s62, 2552
    v_lshlrev_b32 v225, 3, v1
    v_accvgpr_write_b32 a234, v225
    v_sub_u32 v225, s62, v225
    v_accvgpr_write_b32 a233, v225
    s_add_u32 s62, s66, 4096
    v_and_b32 v225, 0x70, v29
    v_add_u32 v235, s62, v225
    v_cmp_lt_u32 vcc, 24, v1
    v_mov_b32 v226, 4240
    s_mul_i32 s62, s53, 9280
    v_cndmask_b32 v226, 0, v226, vcc
    s_add_u32 s62, s62, s63
    v_add3_u32 v239, s62, v29, v226
    v_mul_u32_u24 v225, 4640, v7
    v_lshl_add_u32 v225, v6, 7, v225
    v_lshl_add_u32 v225, v4, 4, v225
    s_lshl_b32 s62, s53, 8
    s_add_u32 s63, s62, s63
    v_add_u32 v225, s63, v225
    v_accvgpr_write_b32 a226, v225
    v_lshlrev_b32 v225, 3, v28
    v_lshlrev_b32 v226, 4, v4
    v_sub_u32 v225, v226, v225
    s_add_u32 s63, s62, s66
    s_add_u32 s63, s63, 120
    v_add_u32 v225, s63, v225
    v_accvgpr_write_b32 a227, v225
    s_add_u32 s62, s45, 114688
    v_add_u32 v225, s62, v29
    v_accvgpr_write_b32 a231, v225
    v_xor_b32 v225, 0x1000, v225
    v_accvgpr_write_b32 a232, v225
    s_lshl_b32 s62, s65, 12
    s_lshl_b32 s63, s53, 11
    s_add_u32 s62, s62, s63
    s_add_u32 s41, s62, 0x40000
    s_add_u32 s49, s62, 0x200000
    s_lshr_b32 s62, s65, 5
    s_lshl_b32 s62, s62, 1
    s_add_u32 s62, s62, s53
    s_lshl_b32 s62, s62, 11
    s_and_b32 s63, s65, 31
    s_add_u32 s62, s62, s63
    s_lshl_b32 s62, s62, 2
    s_add_u32 s52, s62, 0xf00000
    s_mov_b32 s62, 0x06543210
    s_mov_b32 s63, 0x00654321
    s_lshl_b32 s66, s7, 2
    s_add_u32 s66, s66, 4
    s_lshr_b64 s[62:63], s[62:63], s66
    s_and_b32 s66, s62, 0xffffff
    s_lshr_b32 s63, s66, 8
    s_lshl_b32 s62, s66, 24
    s_or_b32 s62, s62, s66
    s_lshl_b32 s67, s67, 2
    s_lshr_b64 s[62:63], s[62:63], s67
    s_mov_b32 s67, s62
    v_mov_b32 v26, 0xc0135761
    v_mov_b32 v27, 0xbdd2d3e8
    v_mov_b32 v252, 0
    v_mov_b32 v253, 0
    v_mov_b32 v254, 0
    v_mov_b32 v255, 0
    s_mov_b32 s46, s67
    s_bitcmp1_b32 s4, 1
    s_cselect_b32 s62, 0, 16
    s_lshl_b32 s44, s44, s62
    s_and_b32 s44, s44, 0xffff0000
    s_mov_b32 exec_hi, 0x3ffff
    ds_write_b128 v239, v[252:255]
    s_mov_b64 exec, 0xff
    ds_write_b128 v235, v[252:255]
    s_mov_b64 exec, -1
    buffer_load_dwordx4 v8, s[20:23], s37 offen offset:1024 lds
    v_add_u32 v8, s101, v8
    buffer_load_dwordx4 v9, s[20:23], s38 offen offset:2048 lds
    buffer_load_dwordx4 v9, s[20:23], s39 offen offset:3072 lds
    v_add_u32 v9, s101, v9
    s_waitcnt vmcnt(10) lgkmcnt(0)
    s_barrier
    ds_read_b64_tr_b16 v[96:97], v18 offset:32768
    v_mfma_f32_16x16x32_bf16 v[56:59], v[128:131], v[156:159], v[56:59]
    ds_read_b64_tr_b16 v[98:99], v18 offset:33792
    s_cmp_eq_u32 s0, 1
    s_cselect_b64 exec, s[54:55], 0
    global_load_dword v0, v[230:231], off
    s_mov_b64 exec, -1
    v_mfma_f32_16x16x32_bf16 v[36:39], v[132:135], v[144:147], v[36:39]
    s_add_u32 m0, s45, 0
    ds_read_b128 v[112:115], v10 offset:32768
    v_mfma_f32_16x16x32_bf16 v[44:47], v[132:135], v[148:151], v[44:47]
    ds_read_b128 v[116:119], v10 offset:34816
    buffer_load_dwordx4 v2, s[8:11], s32 offen offset:0  lds
    v_mfma_f32_16x16x32_bf16 v[52:55], v[132:135], v[152:155], v[52:55]
    ds_read_b128 v[120:123], v11 offset:32768
    v_mfma_f32_16x16x32_bf16 v[60:63], v[132:135], v[156:159], v[60:63]
    ds_read_b128 v[124:127], v11 offset:34816
    v_mfma_f32_16x16x32_bf16 v[64:67], v[136:139], v[144:147], v[64:67]
    ds_read_b64_tr_b16 v[100:101], v19 offset:32768
    v_mfma_f32_16x16x32_bf16 v[72:75], v[136:139], v[148:151], v[72:75]
    ds_read_b64_tr_b16 v[102:103], v19 offset:33792
    v_mfma_f32_16x16x32_bf16 v[80:83], v[136:139], v[152:155], v[80:83]
    ds_read_b64_tr_b16 v[104:105], v20 offset:32768
    v_mfma_f32_16x16x32_bf16 v[88:91], v[136:139], v[156:159], v[88:91]
    ds_read_b64_tr_b16 v[106:107], v20 offset:33792
    v_mfma_f32_16x16x32_bf16 v[68:71], v[140:143], v[144:147], v[68:71]
    ds_read_b64_tr_b16 v[108:109], v21 offset:32768
    buffer_load_dwordx4 v3, s[8:11], s33 offen offset:1024  lds
    v_mfma_f32_16x16x32_bf16 v[76:79], v[140:143], v[148:151], v[76:79]
    ds_read_b64_tr_b16 v[110:111], v21 offset:33792
    v_mfma_f32_16x16x32_bf16 v[84:87], v[140:143], v[152:155], v[84:87]
    buffer_load_dwordx4 v2, s[8:11], s34 offen offset:2048  lds
    v_mfma_f32_16x16x32_bf16 v[92:95], v[140:143], v[156:159], v[92:95]
    s_waitcnt lgkmcnt(9)
    v_mfma_f32_16x16x32_bf16 v[32:35], v[96:99], v[112:115], v[32:35]
    s_waitcnt lgkmcnt(8)
    ds_read_b64_tr_b16 v[128:129], v18 offset:40960
    v_mfma_f32_16x16x32_bf16 v[40:43], v[96:99], v[116:119], v[40:43]
    s_waitcnt lgkmcnt(8)
    ds_read_b64_tr_b16 v[130:131], v18 offset:41984
    buffer_load_dwordx4 v3, s[8:11], s35 offen offset:3072  lds
    v_mfma_f32_16x16x32_bf16 v[48:51], v[96:99], v[120:123], v[48:51]
    s_waitcnt lgkmcnt(8)
    ds_read_b128 v[144:147], v12 offset:32768
    v_mfma_f32_16x16x32_bf16 v[56:59], v[96:99], v[124:127], v[56:59]
    s_waitcnt lgkmcnt(7)
    ds_read_b128 v[148:151], v12 offset:34816
    v_mfma_f32_16x16x32_bf16 v[36:39], v[100:103], v[112:115], v[36:39]
    s_add_u32 m0, s45, 16384
    ds_read_b128 v[152:155], v13 offset:32768
    v_mfma_f32_16x16x32_bf16 v[44:47], v[100:103], v[116:119], v[44:47]
    s_add_u32 s64, s64, 1
    ds_read_b128 v[156:159], v13 offset:34816
    s_cmp_eq_u32 s64, 7
    s_cselect_b32 s100, -6, 1
    s_mul_i32 s101, s100, 229376
    s_lshl_b32 s100, s100, 7
    v_add_u32 v2, s100, v2
    v_add_u32 v3, s100, v3
    buffer_load_dwordx4 v8, s[20:23], s36 offen offset:0 lds
    v_mfma_f32_16x16x32_bf16 v[52:55], v[100:103], v[120:123], v[52:55]
    ds_read_b64_tr_b16 v[132:133], v19 offset:40960
L_stub0:
    s_cbranch_execz L_stub1
    s_nop 0
    v_mfma_f32_16x16x32_bf16 v[60:63], v[100:103], v[124:127], v[60:63]
    s_waitcnt lgkmcnt(9)
    ds_read_b64_tr_b16 v[134:135], v19 offset:41984
    v_mfma_f32_16x16x32_bf16 v[64:67], v[104:107], v[112:115], v[64:67]
    ds_read_b64_tr_b16 v[136:137], v20 offset:40960
    v_mfma_f32_16x16x32_bf16 v[72:75], v[104:107], v[116:119], v[72:75]
    ds_read_b64_tr_b16 v[138:139], v20 offset:41984
    v_mfma_f32_16x16x32_bf16 v[80:83], v[104:107], v[120:123], v[80:83]
    ds_read_b64_tr_b16 v[140:141], v21 offset:40960
    v_mfma_f32_16x16x32_bf16 v[88:91], v[104:107], v[124:127], v[88:91]
    s_waitcnt lgkmcnt(11)
    ds_read_b64_tr_b16 v[142:143], v21 offset:41984
    v_mfma_f32_16x16x32_bf16 v[68:71], v[108:111], v[112:115], v[68:71]
    buffer_load_dwordx4 v8, s[20:23], s37 offen offset:1024 lds
    v_mfma_f32_16x16x32_bf16 v[76:79], v[108:111], v[116:119], v[76:79]
    s_cmp_eq_u32 s59, 1
    s_cbranch_scc1 L_cold_3
L_back_4:
    v_mfma_f32_16x16x32_bf16 v[84:87], v[108:111], v[120:123], v[84:87]
    v_add_u32 v8, s101, v8
    buffer_load_dwordx4 v9, s[20:23], s38 offen offset:2048 lds
    v_mfma_f32_16x16x32_bf16 v[92:95], v[108:111], v[124:127], v[92:95]
    s_waitcnt lgkmcnt(9)
    v_mfma_f32_16x16x32_bf16 v[32:35], v[128:131], v[144:147], v[32:35]
    s_waitcnt lgkmcnt(8)
    v_mfma_f32_16x16x32_bf16 v[40:43], v[128:131], v[148:151], v[40:43]
    s_waitcnt lgkmcnt(7)
    buffer_load_dwordx4 v9, s[20:23], s39 offen offset:3072 lds
    v_mfma_f32_16x16x32_bf16 v[48:51], v[128:131], v[152:155], v[48:51]
    s_waitcnt lgkmcnt(6)
    s_waitcnt vmcnt(9) lgkmcnt(0)
    s_barrier
    ds_read_b64_tr_b16 v[96:97], v22 offset:0
    v_mfma_f32_16x16x32_bf16 v[56:59], v[128:131], v[156:159], v[56:59]
    ds_read_b64_tr_b16 v[98:99], v22 offset:1024
    v_add_u32 v9, s101, v9
    s_cmp_eq_u32 s0, 2
    s_cselect_b64 exec, s[54:55], 0
    global_load_dword v0, v[230:231], off
    s_mov_b64 exec, -1
    v_mfma_f32_16x16x32_bf16 v[36:39], v[132:135], v[144:147], v[36:39]
    s_add_u32 m0, s45, 32768
    ds_read_b128 v[112:115], v14 offset:0
    v_mfma_f32_16x16x32_bf16 v[44:47], v[132:135], v[148:151], v[44:47]
    ds_read_b128 v[116:119], v14 offset:2048
    buffer_load_dwordx4 v2, s[8:11], s32 offen offset:0  lds
    v_mfma_f32_16x16x32_bf16 v[52:55], v[132:135], v[152:155], v[52:55]
    ds_read_b128 v[120:123], v15 offset:0
    v_mfma_f32_16x16x32_bf16 v[60:63], v[132:135], v[156:159], v[60:63]
    ds_read_b128 v[124:127], v15 offset:2048
    v_mfma_f32_16x16x32_bf16 v[64:67], v[136:139], v[144:147], v[64:67]
    ds_read_b64_tr_b16 v[100:101], v23 offset:0
    v_mfma_f32_16x16x32_bf16 v[72:75], v[136:139], v[148:151], v[72:75]
    ds_read_b64_tr_b16 v[102:103], v23 offset:1024
    v_mfma_f32_16x16x32_bf16 v[80:83], v[136:139], v[152:155], v[80:83]
    ds_read_b64_tr_b16 v[104:105], v24 offset:0
    v_mfma_f32_16x16x32_bf16 v[88:91], v[136:139], v[156:159], v[88:91]
    ds_read_b64_tr_b16 v[106:107], v24 offset:1024
    v_mfma_f32_16x16x32_bf16 v[68:71], v[140:143], v[144:147], v[68:71]
    ds_read_b64_tr_b16 v[108:109], v25 offset:0
    buffer_load_dwordx4 v3, s[8:11], s33 offen offset:1024  lds
    v_mfma_f32_16x16x32_bf16 v[76:79], v[140:143], v[148:151], v[76:79]
    ds_read_b64_tr_b16 v[110:111], v25 offset:1024
    v_mfma_f32_16x16x32_bf16 v[84:87], v[140:143], v[152:155], v[84:87]
    buffer_load_dwordx4 v2, s[8:11], s34 offen offset:2048  lds
    v_mfma_f32_16x16x32_bf16 v[92:95], v[140:143], v[156:159], v[92:95]
    s_waitcnt lgkmcnt(9)
    v_mfma_f32_16x16x32_bf16 v[32:35], v[96:99], v[112:115], v[32:35]
    s_waitcnt lgkmcnt(8)
    ds_read_b64_tr_b16 v[128:129], v22 offset:8192
    v_mfma_f32_16x16x32_bf16 v[40:43], v[96:99], v[116:119], v[40:43]
    s_waitcnt lgkmcnt(8)
    ds_read_b64_tr_b16 v[130:131], v22 offset:9216
    buffer_load_dwordx4 v3, s[8:11], s35 offen offset:3072  lds
    v_mfma_f32_16x16x32_bf16 v[48:51], v[96:99], v[120:123], v[48:51]
    s_waitcnt lgkmcnt(8)
    ds_read_b128 v[144:147], v16 offset:0
    v_mfma_f32_16x16x32_bf16 v[56:59], v[96:99], v[124:127], v[56:59]
    s_waitcnt lgkmcnt(7)
    ds_read_b128 v[148:151], v16 offset:2048
    v_mfma_f32_16x16x32_bf16 v[36:39], v[100:103], v[112:115], v[36:39]
    s_add_u32 m0, s45, 49152
    ds_read_b128 v[152:155], v17 offset:0
    v_mfma_f32_16x16x32_bf16 v[44:47], v[100:103], v[116:119], v[44:47]
    s_add_u32 s64, s64, 1
    ds_read_b128 v[156:159], v17 offset:2048
    s_cmp_eq_u32 s64, 7
    s_cselect_b32 s100, -6, 1
    s_mul_i32 s101, s100, 229376
    s_lshl_b32 s100, s100, 7
    v_add_u32 v2, s100, v2
    v_add_u32 v3, s100, v3
    buffer_load_dwordx4 v8, s[20:23], s36 offen offset:0 lds
    v_mfma_f32_16x16x32_bf16 v[52:55], v[100:103], v[120:123], v[52:55]
    ds_read_b64_tr_b16 v[132:133], v23 offset:8192
    v_mfma_f32_16x16x32_bf16 v[60:63], v[100:103], v[124:127], v[60:63]
    s_waitcnt lgkmcnt(9)
    ds_read_b64_tr_b16 v[134:135], v23 offset:9216
    v_mfma_f32_16x16x32_bf16 v[64:67], v[104:107], v[112:115], v[64:67]
    ds_read_b64_tr_b16 v[136:137], v24 offset:8192
    v_mfma_f32_16x16x32_bf16 v[72:75], v[104:107], v[116:119], v[72:75]
    ds_read_b64_tr_b16 v[138:139], v24 offset:9216
    v_mfma_f32_16x16x32_bf16 v[80:83], v[104:107], v[120:123], v[80:83]
    ds_read_b64_tr_b16 v[140:141], v25 offset:8192
    v_mfma_f32_16x16x32_bf16 v[88:91], v[104:107], v[124:127], v[88:91]
    s_waitcnt lgkmcnt(11)
    ds_read_b64_tr_b16 v[142:143], v25 offset:9216
    v_mfma_f32_16x16x32_bf16 v[68:71], v[108:111], v[112:115], v[68:71]
    buffer_load_dwordx4 v8, s[20:23], s37 offen offset:1024 lds
    v_mfma_f32_16x16x32_bf16 v[76:79], v[108:111], v[116:119], v[76:79]
    s_cmp_eq_u32 s59, 2
    s_cbranch_scc1 L_cold_5
L_back_6:
    v_mfma_f32_16x16x32_bf16 v[84:87], v[108:111], v[120:123], v[84:87]
    v_add_u32 v8, s101, v8
    buffer_load_dwordx4 v9, s[20:23], s38 offen offset:2048 lds
    v_mfma_f32_16x16x32_bf16 v[92:95], v[108:111], v[124:127], v[92:95]
    s_waitcnt lgkmcnt(9)
    v_mfma_f32_16x16x32_bf16 v[32:35], v[128:131], v[144:147], v[32:35]
    s_waitcnt lgkmcnt(8)
    v_mfma_f32_16x16x32_bf16 v[40:43], v[128:131], v[148:151], v[40:43]
    s_waitcnt lgkmcnt(7)
    buffer_load_dwordx4 v9, s[20:23], s39 offen offset:3072 lds
    v_mfma_f32_16x16x32_bf16 v[48:51], v[128:131], v[152:155], v[48:51]
    s_waitcnt lgkmcnt(6)
    s_waitcnt vmcnt(9) lgkmcnt(0)
    s_barrier
    ds_read_b64_tr_b16 v[96:97], v18 offset:0
    v_mfma_f32_16x16x32_bf16 v[56:59], v[128:131], v[156:159], v[56:59]
    ds_read_b64_tr_b16 v[98:99], v18 offset:1024
    v_add_u32 v9, s101, v9
    s_cmp_eq_u32 s0, 3
    s_cselect_b64 exec, s[54:55], 0
    global_load_dword v0, v[230:231], off
    s_mov_b64 exec, -1
    v_mfma_f32_16x16x32_bf16 v[36:39], v[132:135], v[144:147], v[36:39]
    s_add_u32 m0, s45, 65536
    ds_read_b128 v[112:115], v10 offset:0
    v_mfma_f32_16x16x32_bf16 v[44:47], v[132:135], v[148:151], v[44:47]
    ds_read_b128 v[116:119], v10 offset:2048
    buffer_load_dwordx4 v2, s[8:11], s32 offen offset:0  lds
    v_mfma_f32_16x16x32_bf16 v[52:55], v[132:135], v[152:155], v[52:55]
    ds_read_b128 v[120:123], v11 offset:0
    v_mfma_f32_16x16x32_bf16 v[60:63], v[132:135], v[156:159], v[60:63]
    ds_read_b128 v[124:127], v11 offset:2048
    v_mfma_f32_16x16x32_bf16 v[64:67], v[136:139], v[144:147], v[64:67]
    ds_read_b64_tr_b16 v[100:101], v19 offset:0
    v_mfma_f32_16x16x32_bf16 v[72:75], v[136:139], v[148:151], v[72:75]
    ds_read_b64_tr_b16 v[102:103], v19 offset:1024
    v_mfma_f32_16x16x32_bf16 v[80:83], v[136:139], v[152:155], v[80:83]
    ds_read_b64_tr_b16 v[104:105], v20 offset:0
    v_mfma_f32_16x16x32_bf16 v[88:91], v[136:139], v[156:159], v[88:91]
    ds_read_b64_tr_b16 v[106:107], v20 offset:1024
    v_mfma_f32_16x16x32_bf16 v[68:71], v[140:143], v[144:147], v[68:71]
    ds_read_b64_tr_b16 v[108:109], v21 offset:0
    buffer_load_dwordx4 v3, s[8:11], s33 offen offset:1024  lds
    v_mfma_f32_16x16x32_bf16 v[76:79], v[140:143], v[148:151], v[76:79]
    ds_read_b64_tr_b16 v[110:111], v21 offset:1024
    v_mfma_f32_16x16x32_bf16 v[84:87], v[140:143], v[152:155], v[84:87]
    buffer_load_dwordx4 v2, s[8:11], s34 offen offset:2048  lds
    v_mfma_f32_16x16x32_bf16 v[92:95], v[140:143], v[156:159], v[92:95]
    s_waitcnt lgkmcnt(9)
    v_mfma_f32_16x16x32_bf16 v[32:35], v[96:99], v[112:115], v[32:35]
    s_waitcnt lgkmcnt(8)
    ds_read_b64_tr_b16 v[128:129], v18 offset:8192
    v_mfma_f32_16x16x32_bf16 v[40:43], v[96:99], v[116:119], v[40:43]
    s_waitcnt lgkmcnt(8)
    ds_read_b64_tr_b16 v[130:131], v18 offset:9216
    buffer_load_dwordx4 v3, s[8:11], s35 offen offset:3072  lds
    v_mfma_f32_16x16x32_bf16 v[48:51], v[96:99], v[120:123], v[48:51]
    s_waitcnt lgkmcnt(8)
    ds_read_b128 v[144:147], v12 offset:0
    v_mfma_f32_16x16x32_bf16 v[56:59], v[96:99], v[124:127], v[56:59]
    s_waitcnt lgkmcnt(7)
    ds_read_b128 v[148:151], v12 offset:2048
    v_mfma_f32_16x16x32_bf16 v[36:39], v[100:103], v[112:115], v[36:39]
    s_add_u32 m0, s45, 81920
    ds_read_b128 v[152:155], v13 offset:0
    v_mfma_f32_16x16x32_bf16 v[44:47], v[100:103], v[116:119], v[44:47]
    s_add_u32 s64, s64, 1
    ds_read_b128 v[156:159], v13 offset:2048
    s_cmp_eq_u32 s64, 7
    s_cselect_b32 s100, -6, 1
    s_mul_i32 s101, s100, 229376
    s_lshl_b32 s100, s100, 7
    v_add_u32 v2, s100, v2
    v_add_u32 v3, s100, v3
    buffer_load_dwordx4 v8, s[20:23], s36 offen offset:0 lds
    v_mfma_f32_16x16x32_bf16 v[52:55], v[100:103], v[120:123], v[52:55]
    ds_read_b64_tr_b16 v[132:133], v19 offset:8192
    v_mfma_f32_16x16x32_bf16 v[60:63], v[100:103], v[124:127], v[60:63]
    s_waitcnt lgkmcnt(9)
    ds_read_b64_tr_b16 v[134:135], v19 offset:9216
    v_mfma_f32_16x16x32_bf16 v[64:67], v[104:107], v[112:115], v[64:67]
    ds_read_b64_tr_b16 v[136:137], v20 offset:8192
    v_mfma_f32_16x16x32_bf16 v[72:75], v[104:107], v[116:119], v[72:75]
    ds_read_b64_tr_b16 v[138:139], v20 offset:9216
    v_mfma_f32_16x16x32_bf16 v[80:83], v[104:107], v[120:123], v[80:83]
    ds_read_b64_tr_b16 v[140:141], v21 offset:8192
    v_mfma_f32_16x16x32_bf16 v[88:91], v[104:107], v[124:127], v[88:91]
    s_waitcnt lgkmcnt(11)
    ds_read_b64_tr_b16 v[142:143], v21 offset:9216
    v_mfma_f32_16x16x32_bf16 v[68:71], v[108:111], v[112:115], v[68:71]
    buffer_load_dwordx4 v8, s[20:23], s37 offen offset:1024 lds
    v_mfma_f32_16x16x32_bf16 v[76:79], v[108:111], v[116:119], v[76:79]
    s_cmp_eq_u32 s59, 3
    s_cbranch_scc1 L_cold_7
L_back_8:
    v_mfma_f32_16x16x32_bf16 v[84:87], v[108:111], v[120:123], v[84:87]
    v_add_u32 v8, s101, v8
    buffer_load_dwordx4 v9, s[20:23], s38 offen offset:2048 lds
    v_mfma_f32_16x16x32_bf16 v[92:95], v[108:111], v[124:127], v[92:95]
    s_waitcnt lgkmcnt(9)
    v_mfma_f32_16x16x32_bf16 v[32:35], v[128:131], v[144:147], v[32:35]
    s_waitcnt lgkmcnt(8)
    v_mfma_f32_16x16x32_bf16 v[40:43], v[128:131], v[148:151], v[40:43]
    s_waitcnt lgkmcnt(7)
    buffer_load_dwordx4 v9, s[20:23], s39 offen offset:3072 lds
    v_mfma_f32_16x16x32_bf16 v[48:51], v[128:131], v[152:155], v[48:51]
    s_waitcnt lgkmcnt(6)
    s_waitcnt vmcnt(9) lgkmcnt(0)
    s_barrier
    ds_read_b64_tr_b16 v[96:97], v18 offset:32768
    v_mfma_f32_16x16x32_bf16 v[56:59], v[128:131], v[156:159], v[56:59]
    ds_read_b64_tr_b16 v[98:99], v18 offset:33792
    v_add_u32 v9, s101, v9
    s_add_u32 m0, s45, 0
    s_nop 0
    buffer_load_dwordx4 v2, s[8:11], s32 offen offset:0  lds
    v_mfma_f32_16x16x32_bf16 v[36:39], v[132:135], v[144:147], v[36:39]
    ds_read_b128 v[112:115], v10 offset:32768
    v_mfma_f32_16x16x32_bf16 v[44:47], v[132:135], v[148:151], v[44:47]
    ds_read_b128 v[116:119], v10 offset:34816
    buffer_load_dwordx4 v3, s[8:11], s33 offen offset:1024  lds
    v_mfma_f32_16x16x32_bf16 v[52:55], v[132:135], v[152:155], v[52:55]
    ds_read_b128 v[120:123], v11 offset:32768
    v_mfma_f32_16x16x32_bf16 v[60:63], v[132:135], v[156:159], v[60:63]
    ds_read_b128 v[124:127], v11 offset:34816
    buffer_load_dwordx4 v2, s[8:11], s34 offen offset:2048  lds
    v_mfma_f32_16x16x32_bf16 v[64:67], v[136:139], v[144:147], v[64:67]
    ds_read_b64_tr_b16 v[100:101], v19 offset:32768
    v_mfma_f32_16x16x32_bf16 v[72:75], v[136:139], v[148:151], v[72:75]
    ds_read_b64_tr_b16 v[102:103], v19 offset:33792
    buffer_load_dwordx4 v3, s[8:11], s35 offen offset:3072  lds
    v_mfma_f32_16x16x32_bf16 v[80:83], v[136:139], v[152:155], v[80:83]
    s_add_u32 m0, s45, 16384
    ds_read_b64_tr_b16 v[104:105], v20 offset:32768
    v_mfma_f32_16x16x32_bf16 v[88:91], v[136:139], v[156:159], v[88:91]
    ds_read_b64_tr_b16 v[106:107], v20 offset:33792
    v_mfma_f32_16x16x32_bf16 v[68:71], v[140:143], v[144:147], v[68:71]
    ds_read_b64_tr_b16 v[108:109], v21 offset:32768
    buffer_load_dwordx4 v8, s[20:23], s36 offen offset:0 lds
    v_mfma_f32_16x16x32_bf16 v[76:79], v[140:143], v[148:151], v[76:79]
    ds_read_b64_tr_b16 v[110:111], v21 offset:33792
    v_mfma_f32_16x16x32_bf16 v[84:87], v[140:143], v[152:155], v[84:87]
    buffer_load_dwordx4 v8, s[20:23], s37 offen offset:1024 lds
    v_mfma_f32_16x16x32_bf16 v[92:95], v[140:143], v[156:159], v[92:95]
    s_waitcnt lgkmcnt(9)
    v_mfma_f32_16x16x32_bf16 v[32:35], v[96:99], v[112:115], v[32:35]
    s_waitcnt lgkmcnt(8)
    ds_read_b64_tr_b16 v[128:129], v18 offset:40960
    v_mfma_f32_16x16x32_bf16 v[40:43], v[96:99], v[116:119], v[40:43]
    s_waitcnt lgkmcnt(8)
    ds_read_b64_tr_b16 v[130:131], v18 offset:41984
    buffer_load_dwordx4 v9, s[20:23], s38 offen offset:2048 lds
    v_mfma_f32_16x16x32_bf16 v[48:51], v[96:99], v[120:123], v[48:51]
    s_waitcnt lgkmcnt(8)
    ds_read_b128 v[144:147], v12 offset:32768
    v_mfma_f32_16x16x32_bf16 v[56:59], v[96:99], v[124:127], v[56:59]
    s_waitcnt lgkmcnt(7)
    ds_read_b128 v[148:151], v12 offset:34816
    buffer_load_dwordx4 v9, s[20:23], s39 offen offset:3072 lds
    v_mfma_f32_16x16x32_bf16 v[36:39], v[100:103], v[112:115], v[36:39]
    ds_read_b128 v[152:155], v13 offset:32768
    v_mfma_f32_16x16x32_bf16 v[44:47], v[100:103], v[116:119], v[44:47]
    ds_read_b128 v[156:159], v13 offset:34816
    buffer_load_dwordx4 v[208:211], v250, s[12:15], 0 offen
    v_mfma_f32_16x16x32_bf16 v[52:55], v[100:103], v[120:123], v[52:55]
    ds_read_b64_tr_b16 v[132:133], v19 offset:40960
    v_mfma_f32_16x16x32_bf16 v[60:63], v[100:103], v[124:127], v[60:63]
    s_waitcnt lgkmcnt(9)
    ds_read_b64_tr_b16 v[134:135], v19 offset:41984
    v_mfma_f32_16x16x32_bf16 v[64:67], v[104:107], v[112:115], v[64:67]
    ds_read_b64_tr_b16 v[136:137], v20 offset:40960
    v_mfma_f32_16x16x32_bf16 v[72:75], v[104:107], v[116:119], v[72:75]
    ds_read_b64_tr_b16 v[138:139], v20 offset:41984
    v_mfma_f32_16x16x32_bf16 v[80:83], v[104:107], v[120:123], v[80:83]
    ds_read_b64_tr_b16 v[140:141], v21 offset:40960
    v_mfma_f32_16x16x32_bf16 v[88:91], v[104:107], v[124:127], v[88:91]
    s_waitcnt lgkmcnt(11)
    ds_read_b64_tr_b16 v[142:143], v21 offset:41984
    v_mfma_f32_16x16x32_bf16 v[68:71], v[108:111], v[112:115], v[68:71]
    buffer_load_dwordx4 v[216:219], v250, s[12:15], 0 offen offset:1024
    v_mfma_f32_16x16x32_bf16 v[76:79], v[108:111], v[116:119], v[76:79]
    s_cmp_eq_u32 s59, 4
    s_cbranch_scc1 L_cold_9
L_back_10:
    v_mfma_f32_16x16x32_bf16 v[84:87], v[108:111], v[120:123], v[84:87]
    buffer_load_dwordx4 v[212:215], v251, s[12:15], 0 offen
    v_mfma_f32_16x16x32_bf16 v[92:95], v[108:111], v[124:127], v[92:95]
    s_waitcnt lgkmcnt(9)
    v_mfma_f32_16x16x32_bf16 v[32:35], v[128:131], v[144:147], v[32:35]
    s_waitcnt lgkmcnt(8)
    v_mfma_f32_16x16x32_bf16 v[40:43], v[128:131], v[148:151], v[40:43]
    s_waitcnt lgkmcnt(7)
    buffer_load_dwordx4 v[220:223], v250, s[12:15], 0 offen offset:1016
    v_mfma_f32_16x16x32_bf16 v[48:51], v[128:131], v[152:155], v[48:51]
    s_waitcnt lgkmcnt(6)
    s_waitcnt vmcnt(12) lgkmcnt(0)
    s_barrier
    ds_read_b64_tr_b16 v[96:97], v22 offset:0
    v_mfma_f32_16x16x32_bf16 v[56:59], v[128:131], v[156:159], v[56:59]
    s_mul_i32 s65, s58, 18400
    ds_read_b64_tr_b16 v[98:99], v22 offset:1024
    v_mfma_f32_16x16x32_bf16 v[36:39], v[132:135], v[144:147], v[36:39]
    s_lshl_b32 s66, s53, 11
    ds_read_b128 v[112:115], v14 offset:0
    v_mfma_f32_16x16x32_bf16 v[44:47], v[132:135], v[148:151], v[44:47]
    s_add_u32 s65, s65, s66
    ds_read_b128 v[116:119], v14 offset:2048
    s_add_u32 m0, s65, 128992
    s_nop 0
    buffer_load_dwordx4 v250, s[12:15], 0 offen offset:0 lds
    v_mfma_f32_16x16x32_bf16 v[52:55], v[132:135], v[152:155], v[52:55]
    ds_read_b128 v[120:123], v15 offset:0
    v_mfma_f32_16x16x32_bf16 v[60:63], v[132:135], v[156:159], v[60:63]
    ds_read_b128 v[124:127], v15 offset:2048
    v_mfma_f32_16x16x32_bf16 v[64:67], v[136:139], v[144:147], v[64:67]
    ds_read_b64_tr_b16 v[100:101], v23 offset:0
    v_mfma_f32_16x16x32_bf16 v[72:75], v[136:139], v[148:151], v[72:75]
    ds_read_b64_tr_b16 v[102:103], v23 offset:1024
    v_mfma_f32_16x16x32_bf16 v[80:83], v[136:139], v[152:155], v[80:83]
    ds_read_b64_tr_b16 v[104:105], v24 offset:0
    v_mfma_f32_16x16x32_bf16 v[88:91], v[136:139], v[156:159], v[88:91]
    ds_read_b64_tr_b16 v[106:107], v24 offset:1024
    v_mfma_f32_16x16x32_bf16 v[68:71], v[140:143], v[144:147], v[68:71]
    ds_read_b64_tr_b16 v[108:109], v25 offset:0
    buffer_load_dwordx4 v250, s[12:15], 0 offen offset:1024 lds
    v_mfma_f32_16x16x32_bf16 v[76:79], v[140:143], v[148:151], v[76:79]
    s_add_u32 m0, s65, 119716
    ds_read_b64_tr_b16 v[110:111], v25 offset:1024
    v_mfma_f32_16x16x32_bf16 v[84:87], v[140:143], v[152:155], v[84:87]
    buffer_load_dwordx4 v250, s[12:15], 0 offen offset:0 lds
    v_mfma_f32_16x16x32_bf16 v[92:95], v[140:143], v[156:159], v[92:95]
    s_waitcnt lgkmcnt(9)
    v_mfma_f32_16x16x32_bf16 v[32:35], v[96:99], v[112:115], v[32:35]
    s_waitcnt lgkmcnt(8)
    ds_read_b64_tr_b16 v[128:129], v22 offset:8192
    v_mfma_f32_16x16x32_bf16 v[40:43], v[96:99], v[116:119], v[40:43]
    s_waitcnt lgkmcnt(8)
    ds_read_b64_tr_b16 v[130:131], v22 offset:9216
    buffer_load_dwordx4 v250, s[12:15], 0 offen offset:1024 lds
    v_mfma_f32_16x16x32_bf16 v[48:51], v[96:99], v[120:123], v[48:51]
    s_waitcnt lgkmcnt(8)
    ds_read_b128 v[144:147], v16 offset:0
    v_mfma_f32_16x16x32_bf16 v[56:59], v[96:99], v[124:127], v[56:59]
    s_waitcnt lgkmcnt(7)
    ds_read_b128 v[148:151], v16 offset:2048
    v_mfma_f32_16x16x32_bf16 v[36:39], v[100:103], v[112:115], v[36:39]
    s_bfe_u32 s65, s46, 0x40004
    ds_read_b128 v[152:155], v17 offset:0
    v_mfma_f32_16x16x32_bf16 v[44:47], v[100:103], v[116:119], v[44:47]
    s_mul_i32 s65, s65, 114688
    ds_read_b128 v[156:159], v17 offset:2048
    s_add_u32 m0, s45, 32768
    s_nop 0
    buffer_load_dwordx4 v249, s[28:31], s65 offen offset:0 lds
    v_mfma_f32_16x16x32_bf16 v[52:55], v[100:103], v[120:123], v[52:55]
    s_add_u32 s65, s65, 6144
    ds_read_b64_tr_b16 v[132:133], v23 offset:8192
    v_mfma_f32_16x16x32_bf16 v[60:63], v[100:103], v[124:127], v[60:63]
    s_waitcnt lgkmcnt(9)
    ds_read_b64_tr_b16 v[134:135], v23 offset:9216
    v_mfma_f32_16x16x32_bf16 v[64:67], v[104:107], v[112:115], v[64:67]
    ds_read_b64_tr_b16 v[136:137], v24 offset:8192
    v_mfma_f32_16x16x32_bf16 v[72:75], v[104:107], v[116:119], v[72:75]
    ds_read_b64_tr_b16 v[138:139], v24 offset:9216
    v_mfma_f32_16x16x32_bf16 v[80:83], v[104:107], v[120:123], v[80:83]
    ds_read_b64_tr_b16 v[140:141], v25 offset:8192
    v_mfma_f32_16x16x32_bf16 v[88:91], v[104:107], v[124:127], v[88:91]
    s_waitcnt lgkmcnt(11)
    ds_read_b64_tr_b16 v[142:143], v25 offset:9216
    v_mfma_f32_16x16x32_bf16 v[68:71], v[108:111], v[112:115], v[68:71]
    buffer_load_dwordx4 v249, s[28:31], s65 offen offset:1024 lds
    v_mfma_f32_16x16x32_bf16 v[76:79], v[108:111], v[116:119], v[76:79]
    s_add_u32 s65, s65, 6144
    s_cmp_eq_u32 s59, 5
    s_cbranch_scc1 L_cold_11
L_back_12:
    v_mfma_f32_16x16x32_bf16 v[84:87], v[108:111], v[120:123], v[84:87]
    buffer_load_dwordx4 v249, s[28:31], s65 offen offset:2048 lds
    v_mfma_f32_16x16x32_bf16 v[92:95], v[108:111], v[124:127], v[92:95]
    s_waitcnt lgkmcnt(9)
    v_mfma_f32_16x16x32_bf16 v[32:35], v[128:131], v[144:147], v[32:35]
    s_waitcnt lgkmcnt(8)
    v_mfma_f32_16x16x32_bf16 v[40:43], v[128:131], v[148:151], v[40:43]
    s_waitcnt lgkmcnt(7)
    s_add_u32 s65, s65, 6144
    buffer_load_dwordx4 v249, s[28:31], s65 offen offset:3072 lds
    v_mfma_f32_16x16x32_bf16 v[48:51], v[128:131], v[152:155], v[48:51]
    s_waitcnt lgkmcnt(6)
    s_waitcnt vmcnt(12) lgkmcnt(0)
    s_barrier
    ds_read_b64_tr_b16 v[96:97], v18 offset:0
    s_lshl_b32 s32, s7, 12
    v_mfma_f32_16x16x32_bf16 v[56:59], v[128:131], v[156:159], v[56:59]
    s_bfe_u32 s65, s46, 0x40008
    ds_read_b64_tr_b16 v[98:99], v18 offset:1024
    s_bfe_u32 s62, s46, 0x40000
    v_mfma_f32_16x16x32_bf16 v[36:39], v[132:135], v[144:147], v[36:39]
    s_mul_i32 s65, s65, 114688
    ds_read_b128 v[112:115], v10 offset:0
    s_lshl_b32 s33, s62, 12
    v_mfma_f32_16x16x32_bf16 v[44:47], v[132:135], v[148:151], v[44:47]
    s_add_u32 m0, s45, 49152
    ds_read_b128 v[116:119], v10 offset:2048
    buffer_load_dwordx4 v249, s[28:31], s65 offen offset:0 lds
    v_mfma_f32_16x16x32_bf16 v[52:55], v[132:135], v[152:155], v[52:55]
    s_add_u32 s65, s65, 6144
    ds_read_b128 v[120:123], v11 offset:0
    s_bfe_u32 s62, s46, 0x40004
    v_mfma_f32_16x16x32_bf16 v[60:63], v[132:135], v[156:159], v[60:63]
    s_lshl_b32 s34, s62, 12
    ds_read_b128 v[124:127], v11 offset:2048
    s_bfe_u32 s62, s46, 0x40008
    v_mfma_f32_16x16x32_bf16 v[64:67], v[136:139], v[144:147], v[64:67]
    s_lshl_b32 s35, s62, 12
    ds_read_b64_tr_b16 v[100:101], v19 offset:0
    s_bfe_u32 s62, s46, 0x4000c
    v_mfma_f32_16x16x32_bf16 v[72:75], v[136:139], v[148:151], v[72:75]
    s_lshl_b32 s36, s62, 12
    ds_read_b64_tr_b16 v[102:103], v19 offset:1024
    s_bfe_u32 s62, s46, 0x40010
    v_mfma_f32_16x16x32_bf16 v[80:83], v[136:139], v[152:155], v[80:83]
    s_lshl_b32 s37, s62, 12
    ds_read_b64_tr_b16 v[104:105], v20 offset:0
    s_bfe_u32 s62, s46, 0x40014
    v_mfma_f32_16x16x32_bf16 v[88:91], v[136:139], v[156:159], v[88:91]
    s_lshl_b32 s38, s62, 12
    ds_read_b64_tr_b16 v[106:107], v20 offset:1024
    v_mfma_f32_16x16x32_bf16 v[68:71], v[140:143], v[144:147], v[68:71]
    ds_read_b64_tr_b16 v[108:109], v21 offset:0
    buffer_load_dwordx4 v249, s[28:31], s65 offen offset:1024 lds
    v_mfma_f32_16x16x32_bf16 v[76:79], v[140:143], v[148:151], v[76:79]
    s_add_u32 s65, s65, 6144
    ds_read_b64_tr_b16 v[110:111], v21 offset:1024
    v_mfma_f32_16x16x32_bf16 v[84:87], v[140:143], v[152:155], v[84:87]
    buffer_load_dwordx4 v249, s[28:31], s65 offen offset:2048 lds
    v_mfma_f32_16x16x32_bf16 v[92:95], v[140:143], v[156:159], v[92:95]
    s_waitcnt lgkmcnt(9)
    v_mfma_f32_16x16x32_bf16 v[32:35], v[96:99], v[112:115], v[32:35]
    s_waitcnt lgkmcnt(8)
    ds_read_b64_tr_b16 v[128:129], v18 offset:8192
    v_mfma_f32_16x16x32_bf16 v[40:43], v[96:99], v[116:119], v[40:43]
    s_waitcnt lgkmcnt(8)
    ds_read_b64_tr_b16 v[130:131], v18 offset:9216
    s_add_u32 s65, s65, 6144
    buffer_load_dwordx4 v249, s[28:31], s65 offen offset:3072 lds
    v_mfma_f32_16x16x32_bf16 v[48:51], v[96:99], v[120:123], v[48:51]
    s_waitcnt lgkmcnt(8)
    ds_read_b128 v[144:147], v12 offset:0
    v_mfma_f32_16x16x32_bf16 v[56:59], v[96:99], v[124:127], v[56:59]
    s_waitcnt lgkmcnt(7)
    ds_read_b128 v[148:151], v12 offset:2048
    v_mfma_f32_16x16x32_bf16 v[36:39], v[100:103], v[112:115], v[36:39]
    s_bfe_u32 s65, s46, 0x4000c
    ds_read_b128 v[152:155], v13 offset:0
    v_mfma_f32_16x16x32_bf16 v[44:47], v[100:103], v[116:119], v[44:47]
    s_mul_i32 s65, s65, 114688
    ds_read_b128 v[156:159], v13 offset:2048
    s_add_u32 m0, s45, 65536
    s_nop 0
    buffer_load_dwordx4 v249, s[28:31], s65 offen offset:0 lds
    v_mfma_f32_16x16x32_bf16 v[52:55], v[100:103], v[120:123], v[52:55]
    s_add_u32 s65, s65, 6144
    ds_read_b64_tr_b16 v[132:133], v19 offset:8192
    v_mfma_f32_16x16x32_bf16 v[60:63], v[100:103], v[124:127], v[60:63]
    s_waitcnt lgkmcnt(9)
    ds_read_b64_tr_b16 v[134:135], v19 offset:9216
    v_mfma_f32_16x16x32_bf16 v[64:67], v[104:107], v[112:115], v[64:67]
    ds_read_b64_tr_b16 v[136:137], v20 offset:8192
    v_mfma_f32_16x16x32_bf16 v[72:75], v[104:107], v[116:119], v[72:75]
    ds_read_b64_tr_b16 v[138:139], v20 offset:9216
    v_mfma_f32_16x16x32_bf16 v[80:83], v[104:107], v[120:123], v[80:83]
    ds_read_b64_tr_b16 v[140:141], v21 offset:8192
    v_mfma_f32_16x16x32_bf16 v[88:91], v[104:107], v[124:127], v[88:91]
    s_waitcnt lgkmcnt(11)
    ds_read_b64_tr_b16 v[142:143], v21 offset:9216
    v_mfma_f32_16x16x32_bf16 v[68:71], v[108:111], v[112:115], v[68:71]
    buffer_load_dwordx4 v249, s[28:31], s65 offen offset:1024 lds
    v_mfma_f32_16x16x32_bf16 v[76:79], v[108:111], v[116:119], v[76:79]
    s_add_u32 s65, s65, 6144
    s_cmp_eq_u32 s59, 6
    s_cbranch_scc1 L_cold_13
L_back_14:
    v_mfma_f32_16x16x32_bf16 v[84:87], v[108:111], v[120:123], v[84:87]
    buffer_load_dwordx4 v249, s[28:31], s65 offen offset:2048 lds
    v_mfma_f32_16x16x32_bf16 v[92:95], v[108:111], v[124:127], v[92:95]
    s_waitcnt lgkmcnt(9)
    v_mfma_f32_16x16x32_bf16 v[32:35], v[128:131], v[144:147], v[32:35]
    s_waitcnt lgkmcnt(8)
    v_mfma_f32_16x16x32_bf16 v[40:43], v[128:131], v[148:151], v[40:43]
    s_waitcnt lgkmcnt(7)
    s_add_u32 s65, s65, 6144
    buffer_load_dwordx4 v249, s[28:31], s65 offen offset:3072 lds
    v_mfma_f32_16x16x32_bf16 v[48:51], v[128:131], v[152:155], v[48:51]
    s_waitcnt lgkmcnt(6)
    s_waitcnt lgkmcnt(0)
    s_barrier
    s_waitcnt vmcnt(16)
    v_alignbyte_b32 v160, v208, v213, 2
    v_alignbyte_b32 v161, v209, v208, 2
    v_alignbyte_b32 v162, v210, v209, 2
    v_alignbyte_b32 v163, v211, v210, 2
    v_alignbyte_b32 v168, v213, v212, 2
    v_alignbyte_b32 v169, v208, v213, 2
    v_alignbyte_b32 v170, v209, v208, 2
    v_alignbyte_b32 v171, v210, v209, 2
    v_alignbyte_b32 v172, v216, v221, 2
    v_alignbyte_b32 v173, v217, v216, 2
    v_alignbyte_b32 v174, v218, v217, 2
    v_alignbyte_b32 v175, v219, v218, 2
    v_alignbyte_b32 v180, v221, v220, 2
    v_alignbyte_b32 v181, v216, v221, 2
    v_alignbyte_b32 v182, v217, v216, 2
    v_alignbyte_b32 v183, v218, v217, 2
    v_mfma_f32_16x16x32_bf16 v[96:99], v[200:203], v[184:187], 0
    v_mfma_f32_16x16x32_bf16 v[100:103], v[200:203], v[188:191], 0
    v_mfma_f32_16x16x32_bf16 v[56:59], v[128:131], v[156:159], v[56:59]
    s_bfe_u32 s65, s46, 0x40010
    v_accvgpr_read_b32 v5, a238
    v_mfma_f32_16x16x32_bf16 v[96:99], v[204:207], v[192:195], v[96:99]
    v_mfma_f32_16x16x32_bf16 v[36:39], v[132:135], v[144:147], v[36:39]
    s_mul_i32 s65, s65, 114688
    v_mfma_f32_16x16x32_bf16 v[100:103], v[204:207], v[196:199], v[100:103]
    v_accvgpr_read_b32 v12, a226
    v_mfma_f32_16x16x32_bf16 v[44:47], v[132:135], v[148:151], v[44:47]
    s_add_u32 m0, s45, 81920
    s_nop 0
    buffer_load_dwordx4 v249, s[28:31], s65 offen offset:0 lds
    v_accvgpr_read_b32 v13, a227
    v_mfma_f32_16x16x32_bf16 v[52:55], v[132:135], v[152:155], v[52:55]
    s_add_u32 s65, s65, 6144
    v_accvgpr_read_b32 v25, a228
    v_accvgpr_read_b32 v10, a229
    v_mfma_f32_16x16x32_bf16 v[60:63], v[132:135], v[156:159], v[60:63]
    v_accvgpr_read_b32 v11, a230
    v_mov_b32 v248, 0
    v_mfma_f32_16x16x32_bf16 v[64:67], v[136:139], v[144:147], v[64:67]
    v_xor_b32 v0, 0x400, v10
    v_xor_b32 v22, 0x400, v11
    v_mfma_f32_16x16x32_bf16 v[72:75], v[136:139], v[148:151], v[72:75]
    v_mov_b32 v99, v100
    s_mov_b64 exec, 0xffff
    buffer_store_dwordx2 v[98:99], v5, s[24:27], s40 offen sc1
    s_mov_b64 exec, -1
    v_mfma_f32_16x16x32_bf16 v[80:83], v[136:139], v[152:155], v[80:83]
    v_mfma_f32_16x16x32_bf16 v[88:91], v[136:139], v[156:159], v[88:91]
    v_mfma_f32_16x16x32_bf16 v[68:71], v[140:143], v[144:147], v[68:71]
    buffer_load_dwordx4 v249, s[28:31], s65 offen offset:1024 lds
    v_mfma_f32_16x16x32_bf16 v[76:79], v[140:143], v[148:151], v[76:79]
    s_add_u32 s65, s65, 6144
    v_mfma_f32_16x16x32_bf16 v[84:87], v[140:143], v[152:155], v[84:87]
    buffer_load_dwordx4 v249, s[28:31], s65 offen offset:2048 lds
    v_mfma_f32_16x16x32_bf16 v[92:95], v[140:143], v[156:159], v[92:95]
    s_add_u32 s65, s65, 6144
    v_mov_b32 v232, v31
    s_mov_b32 exec_hi, 0
    v_mov_b32 v232, 0
    global_atomic_or v232, v234, v30, s[24:25] sc0 sc1
    s_mov_b64 exec, -1
    v_pk_mul_f32 v[128:129], v[32:33], v[32:33]
    v_pk_mul_f32 v[130:131], v[34:35], v[34:35]
    v_pk_mul_f32 v[132:133], v[36:37], v[36:37]
    v_pk_mul_f32 v[134:135], v[38:39], v[38:39]
    v_pk_fma_f32 v[128:129], v[128:129], v[26:27], v[26:27] op_sel:[0,1,0] op_sel_hi:[1,1,0]
    v_pk_fma_f32 v[130:131], v[130:131], v[26:27], v[26:27] op_sel:[0,1,0] op_sel_hi:[1,1,0]
    v_pk_fma_f32 v[132:133], v[132:133], v[26:27], v[26:27] op_sel:[0,1,0] op_sel_hi:[1,1,0]
    v_pk_fma_f32 v[134:135], v[134:135], v[26:27], v[26:27] op_sel:[0,1,0] op_sel_hi:[1,1,0]
    v_pk_mul_f32 v[128:129], v[128:129], v[32:33]
    v_pk_mul_f32 v[130:131], v[130:131], v[34:35]
    v_pk_mul_f32 v[132:133], v[132:133], v[36:37]
    v_pk_mul_f32 v[134:135], v[134:135], v[38:39]
L_stub1:
    s_cbranch_execz L_tour_back
    s_nop 0
    v_exp_f32 v128, v128
    v_exp_f32 v129, v129
    v_exp_f32 v130, v130
    v_exp_f32 v131, v131
    v_exp_f32 v132, v132
    v_exp_f32 v133, v133
    v_exp_f32 v134, v134
    v_exp_f32 v135, v135
    v_pk_add_f32 v[128:129], v[128:129], 1.0 op_sel_hi:[1,0]
    v_pk_add_f32 v[130:131], v[130:131], 1.0 op_sel_hi:[1,0]
    v_pk_add_f32 v[132:133], v[132:133], 1.0 op_sel_hi:[1,0]
    v_pk_add_f32 v[134:135], v[134:135], 1.0 op_sel_hi:[1,0]
    v_rcp_f32 v128, v128
    v_rcp_f32 v129, v129
    v_rcp_f32 v130, v130
    v_rcp_f32 v131, v131
    v_rcp_f32 v132, v132
    v_rcp_f32 v133, v133
    v_rcp_f32 v134, v134
    v_rcp_f32 v135, v135
    v_pk_mul_f32 v[128:129], v[128:129], v[32:33]
    v_pk_mul_f32 v[130:131], v[130:131], v[34:35]
    v_pk_mul_f32 v[132:133], v[132:133], v[36:37]
    v_pk_mul_f32 v[134:135], v[134:135], v[38:39]
    v_cvt_pk_bf16_f32 v96, v128, v129
    v_cvt_pk_bf16_f32 v97, v130, v131
    v_cvt_pk_bf16_f32 v98, v132, v133
    v_cvt_pk_bf16_f32 v99, v134, v135
    buffer_store_dwordx4 v[96:99], v29, s[24:27], s42 offen offset:0 sc1
    v_pk_mul_f32 v[144:145], v[40:41], v[40:41]
    v_pk_mul_f32 v[146:147], v[42:43], v[42:43]
    v_pk_mul_f32 v[148:149], v[44:45], v[44:45]
    v_pk_mul_f32 v[150:151], v[46:47], v[46:47]
    v_pk_fma_f32 v[144:145], v[144:145], v[26:27], v[26:27] op_sel:[0,1,0] op_sel_hi:[1,1,0]
    v_pk_fma_f32 v[146:147], v[146:147], v[26:27], v[26:27] op_sel:[0,1,0] op_sel_hi:[1,1,0]
    v_pk_fma_f32 v[148:149], v[148:149], v[26:27], v[26:27] op_sel:[0,1,0] op_sel_hi:[1,1,0]
    v_pk_fma_f32 v[150:151], v[150:151], v[26:27], v[26:27] op_sel:[0,1,0] op_sel_hi:[1,1,0]
    v_pk_mul_f32 v[144:145], v[144:145], v[40:41]
    v_pk_mul_f32 v[146:147], v[146:147], v[42:43]
    v_pk_mul_f32 v[148:149], v[148:149], v[44:45]
    v_pk_mul_f32 v[150:151], v[150:151], v[46:47]
    v_exp_f32 v144, v144
    v_exp_f32 v145, v145
    v_exp_f32 v146, v146
    v_exp_f32 v147, v147
    v_exp_f32 v148, v148
    v_exp_f32 v149, v149
    v_exp_f32 v150, v150
    v_exp_f32 v151, v151
    v_pk_add_f32 v[144:145], v[144:145], 1.0 op_sel_hi:[1,0]
    v_pk_add_f32 v[146:147], v[146:147], 1.0 op_sel_hi:[1,0]
    v_pk_add_f32 v[148:149], v[148:149], 1.0 op_sel_hi:[1,0]
    v_pk_add_f32 v[150:151], v[150:151], 1.0 op_sel_hi:[1,0]
    v_rcp_f32 v144, v144
    v_rcp_f32 v145, v145
    v_rcp_f32 v146, v146
    v_rcp_f32 v147, v147
    v_rcp_f32 v148, v148
    v_rcp_f32 v149, v149
    v_rcp_f32 v150, v150
    v_rcp_f32 v151, v151
    v_pk_mul_f32 v[144:145], v[144:145], v[40:41]
    v_pk_mul_f32 v[146:147], v[146:147], v[42:43]
    v_pk_mul_f32 v[148:149], v[148:149], v[44:45]
    v_pk_mul_f32 v[150:151], v[150:151], v[46:47]
    v_cvt_pk_bf16_f32 v100, v144, v145
    v_cvt_pk_bf16_f32 v101, v146, v147
    v_cvt_pk_bf16_f32 v102, v148, v149
    v_cvt_pk_bf16_f32 v103, v150, v151
    buffer_store_dwordx4 v[100:103], v237, s[24:27], s42 offen offset:0 sc1
    s_mov_b32 exec_hi, 0
    global_atomic_or v232, v234, v30, s[24:25] sc0 sc1
    s_mov_b64 exec, -1
    v_pk_mul_f32 v[128:129], v[48:49], v[48:49]
    v_pk_mul_f32 v[130:131], v[50:51], v[50:51]
    v_pk_mul_f32 v[132:133], v[52:53], v[52:53]
    v_pk_mul_f32 v[134:135], v[54:55], v[54:55]
    v_pk_fma_f32 v[128:129], v[128:129], v[26:27], v[26:27] op_sel:[0,1,0] op_sel_hi:[1,1,0]
    v_pk_fma_f32 v[130:131], v[130:131], v[26:27], v[26:27] op_sel:[0,1,0] op_sel_hi:[1,1,0]
    v_pk_fma_f32 v[132:133], v[132:133], v[26:27], v[26:27] op_sel:[0,1,0] op_sel_hi:[1,1,0]
    v_pk_fma_f32 v[134:135], v[134:135], v[26:27], v[26:27] op_sel:[0,1,0] op_sel_hi:[1,1,0]
    v_pk_mul_f32 v[128:129], v[128:129], v[48:49]
    v_pk_mul_f32 v[130:131], v[130:131], v[50:51]
    v_pk_mul_f32 v[132:133], v[132:133], v[52:53]
    v_pk_mul_f32 v[134:135], v[134:135], v[54:55]
    v_exp_f32 v128, v128
    v_exp_f32 v129, v129
    v_exp_f32 v130, v130
    v_exp_f32 v131, v131
    v_exp_f32 v132, v132
    v_exp_f32 v133, v133
    v_exp_f32 v134, v134
    v_exp_f32 v135, v135
    v_pk_add_f32 v[128:129], v[128:129], 1.0 op_sel_hi:[1,0]
    v_pk_add_f32 v[130:131], v[130:131], 1.0 op_sel_hi:[1,0]
    v_pk_add_f32 v[132:133], v[132:133], 1.0 op_sel_hi:[1,0]
    v_pk_add_f32 v[134:135], v[134:135], 1.0 op_sel_hi:[1,0]
    v_rcp_f32 v128, v128
    v_rcp_f32 v129, v129
    v_rcp_f32 v130, v130
    v_rcp_f32 v131, v131
    v_rcp_f32 v132, v132
    v_rcp_f32 v133, v133
    v_rcp_f32 v134, v134
    v_rcp_f32 v135, v135
    v_pk_mul_f32 v[128:129], v[128:129], v[48:49]
    v_pk_mul_f32 v[130:131], v[130:131], v[50:51]
    v_pk_mul_f32 v[132:133], v[132:133], v[52:53]
    v_pk_mul_f32 v[134:135], v[134:135], v[54:55]
    v_cvt_pk_bf16_f32 v104, v128, v129
    v_cvt_pk_bf16_f32 v105, v130, v131
    v_cvt_pk_bf16_f32 v106, v132, v133
    v_cvt_pk_bf16_f32 v107, v134, v135
    buffer_store_dwordx4 v[104:107], v29, s[24:27], s43 offen offset:0 sc1
    v_accvgpr_write_b32 a0, v96
    v_accvgpr_write_b32 a1, v97
    v_accvgpr_write_b32 a2, v98
    v_accvgpr_write_b32 a3, v99
    v_accvgpr_write_b32 a4, v100
    v_accvgpr_write_b32 a5, v101
    v_accvgpr_write_b32 a6, v102
    v_accvgpr_write_b32 a7, v103
    v_pk_mul_f32 v[144:145], v[56:57], v[56:57]
    v_pk_mul_f32 v[146:147], v[58:59], v[58:59]
    v_pk_mul_f32 v[148:149], v[60:61], v[60:61]
    v_pk_mul_f32 v[150:151], v[62:63], v[62:63]
    v_pk_fma_f32 v[144:145], v[144:145], v[26:27], v[26:27] op_sel:[0,1,0] op_sel_hi:[1,1,0]
    v_pk_fma_f32 v[146:147], v[146:147], v[26:27], v[26:27] op_sel:[0,1,0] op_sel_hi:[1,1,0]
    v_pk_fma_f32 v[148:149], v[148:149], v[26:27], v[26:27] op_sel:[0,1,0] op_sel_hi:[1,1,0]
    v_pk_fma_f32 v[150:151], v[150:151], v[26:27], v[26:27] op_sel:[0,1,0] op_sel_hi:[1,1,0]
    v_pk_mul_f32 v[144:145], v[144:145], v[56:57]
    v_pk_mul_f32 v[146:147], v[146:147], v[58:59]
    v_pk_mul_f32 v[148:149], v[148:149], v[60:61]
    v_pk_mul_f32 v[150:151], v[150:151], v[62:63]
    buffer_load_dwordx4 v249, s[28:31], s65 offen offset:3072 lds
    v_exp_f32 v144, v144
    v_exp_f32 v145, v145
    v_exp_f32 v146, v146
    v_exp_f32 v147, v147
    v_exp_f32 v148, v148
    v_exp_f32 v149, v149
    v_exp_f32 v150, v150
    v_exp_f32 v151, v151
    v_pk_add_f32 v[144:145], v[144:145], 1.0 op_sel_hi:[1,0]
    v_pk_add_f32 v[146:147], v[146:147], 1.0 op_sel_hi:[1,0]
    v_pk_add_f32 v[148:149], v[148:149], 1.0 op_sel_hi:[1,0]
    v_pk_add_f32 v[150:151], v[150:151], 1.0 op_sel_hi:[1,0]
    s_mul_i32 s65, s7, 114688
    s_add_u32 m0, s45, 0
    s_nop 0
    buffer_load_dwordx4 v249, s[28:31], s65 offen offset:0 lds
    v_rcp_f32 v144, v144
    v_rcp_f32 v145, v145
    v_rcp_f32 v146, v146
    v_rcp_f32 v147, v147
    v_rcp_f32 v148, v148
    v_rcp_f32 v149, v149
    v_rcp_f32 v150, v150
    v_rcp_f32 v151, v151
    v_pk_mul_f32 v[144:145], v[144:145], v[56:57]
    v_pk_mul_f32 v[146:147], v[146:147], v[58:59]
    v_pk_mul_f32 v[148:149], v[148:149], v[60:61]
    v_pk_mul_f32 v[150:151], v[150:151], v[62:63]
    v_cvt_pk_bf16_f32 v108, v144, v145
    v_cvt_pk_bf16_f32 v109, v146, v147
    v_cvt_pk_bf16_f32 v110, v148, v149
    v_cvt_pk_bf16_f32 v111, v150, v151
    buffer_store_dwordx4 v[108:111], v237, s[24:27], s43 offen offset:0 sc1
    v_cmp_ne_u32 vcc, s3, v232
    s_mov_b32 s101, 0
    s_cbranch_vccnz L_cold_16
L_back_17:
    s_mov_b32 s100, m0
    s_mov_b32 m0, s47
    s_mov_b32 s101, 1
    buffer_load_dwordx4 v29, s[24:27], s41 offen sc1 lds
    buffer_load_dwordx4 v29, s[24:27], s41 offen offset:1024 sc1 lds
    s_mov_b32 m0, s100
L_ks_15:
    s_nop 0
    v_pk_mul_f32 v[128:129], v[64:65], v[64:65]
    v_pk_mul_f32 v[130:131], v[66:67], v[66:67]
    v_pk_mul_f32 v[132:133], v[68:69], v[68:69]
    v_pk_mul_f32 v[134:135], v[70:71], v[70:71]
    v_pk_fma_f32 v[128:129], v[128:129], v[26:27], v[26:27] op_sel:[0,1,0] op_sel_hi:[1,1,0]
    v_pk_fma_f32 v[130:131], v[130:131], v[26:27], v[26:27] op_sel:[0,1,0] op_sel_hi:[1,1,0]
    v_pk_fma_f32 v[132:133], v[132:133], v[26:27], v[26:27] op_sel:[0,1,0] op_sel_hi:[1,1,0]
    v_pk_fma_f32 v[134:135], v[134:135], v[26:27], v[26:27] op_sel:[0,1,0] op_sel_hi:[1,1,0]
    v_pk_mul_f32 v[128:129], v[128:129], v[64:65]
    v_pk_mul_f32 v[130:131], v[130:131], v[66:67]
    v_pk_mul_f32 v[132:133], v[132:133], v[68:69]
    v_pk_mul_f32 v[134:135], v[134:135], v[70:71]
    s_add_u32 s65, s65, 6144
    buffer_load_dwordx4 v249, s[28:31], s65 offen offset:1024 lds
    s_waitcnt vmcnt(8)
    s_mov_b64 exec, 0x1
    buffer_atomic_swap v31, off, s[24:27], s48 offset:0 sc1
    s_mov_b64 exec, -1
    v_exp_f32 v128, v128
    v_exp_f32 v129, v129
    v_exp_f32 v130, v130
    v_exp_f32 v131, v131
    v_exp_f32 v132, v132
    v_exp_f32 v133, v133
    v_exp_f32 v134, v134
    v_exp_f32 v135, v135
    s_nop 0
    v_pk_add_f32 v[128:129], v[128:129], 1.0 op_sel_hi:[1,0]
    v_pk_add_f32 v[130:131], v[130:131], 1.0 op_sel_hi:[1,0]
    v_pk_add_f32 v[132:133], v[132:133], 1.0 op_sel_hi:[1,0]
    v_pk_add_f32 v[134:135], v[134:135], 1.0 op_sel_hi:[1,0]
    s_add_u32 s65, s65, 6144
    buffer_load_dwordx4 v249, s[28:31], s65 offen offset:2048 lds
    v_rcp_f32 v128, v128
    v_rcp_f32 v129, v129
    v_rcp_f32 v130, v130
    v_rcp_f32 v131, v131
    v_rcp_f32 v132, v132
    v_rcp_f32 v133, v133
    v_rcp_f32 v134, v134
    v_rcp_f32 v135, v135
    v_pk_mul_f32 v[128:129], v[128:129], v[64:65]
    v_pk_mul_f32 v[130:131], v[130:131], v[66:67]
    v_pk_mul_f32 v[132:133], v[132:133], v[68:69]
    v_pk_mul_f32 v[134:135], v[134:135], v[70:71]
    v_cvt_pk_bf16_f32 v112, v128, v129
    v_cvt_pk_bf16_f32 v113, v130, v131
    v_cvt_pk_bf16_f32 v114, v132, v133
    v_cvt_pk_bf16_f32 v115, v134, v135
    buffer_store_dwordx4 v[112:115], v29, s[24:27], s42 offen offset:2048 sc1
    s_cmp_eq_u32 s101, 0
    s_cbranch_scc1 L_cold_19
L_back_20:
    v_pk_mul_f32 v[144:145], v[72:73], v[72:73]
    v_pk_mul_f32 v[146:147], v[74:75], v[74:75]
    v_pk_mul_f32 v[148:149], v[76:77], v[76:77]
    v_pk_mul_f32 v[150:151], v[78:79], v[78:79]
    v_pk_fma_f32 v[144:145], v[144:145], v[26:27], v[26:27] op_sel:[0,1,0] op_sel_hi:[1,1,0]
    v_pk_fma_f32 v[146:147], v[146:147], v[26:27], v[26:27] op_sel:[0,1,0] op_sel_hi:[1,1,0]
    v_pk_fma_f32 v[148:149], v[148:149], v[26:27], v[26:27] op_sel:[0,1,0] op_sel_hi:[1,1,0]
    v_pk_fma_f32 v[150:151], v[150:151], v[26:27], v[26:27] op_sel:[0,1,0] op_sel_hi:[1,1,0]
    v_pk_mul_f32 v[144:145], v[144:145], v[72:73]
    v_pk_mul_f32 v[146:147], v[146:147], v[74:75]
    v_pk_mul_f32 v[148:149], v[148:149], v[76:77]
    v_pk_mul_f32 v[150:151], v[150:151], v[78:79]
    s_add_u32 s65, s65, 6144
    buffer_load_dwordx4 v249, s[28:31], s65 offen offset:3072 lds
    v_exp_f32 v144, v144
    v_exp_f32 v145, v145
    v_exp_f32 v146, v146
    v_exp_f32 v147, v147
    v_exp_f32 v148, v148
    v_exp_f32 v149, v149
    v_exp_f32 v150, v150
    v_exp_f32 v151, v151
    v_pk_add_f32 v[144:145], v[144:145], 1.0 op_sel_hi:[1,0]
    v_pk_add_f32 v[146:147], v[146:147], 1.0 op_sel_hi:[1,0]
    v_pk_add_f32 v[148:149], v[148:149], 1.0 op_sel_hi:[1,0]
    v_pk_add_f32 v[150:151], v[150:151], 1.0 op_sel_hi:[1,0]
    s_bfe_u32 s65, s46, 0x40000
    s_mul_i32 s65, s65, 114688
    s_add_u32 m0, s45, 16384
    s_nop 0
    buffer_load_dwordx4 v249, s[28:31], s65 offen offset:0 lds
    v_rcp_f32 v144, v144
    v_rcp_f32 v145, v145
    v_rcp_f32 v146, v146
    v_rcp_f32 v147, v147
    v_rcp_f32 v148, v148
    v_rcp_f32 v149, v149
    v_rcp_f32 v150, v150
    v_rcp_f32 v151, v151
    s_nop 0
    v_pk_mul_f32 v[144:145], v[144:145], v[72:73]
    v_pk_mul_f32 v[146:147], v[146:147], v[74:75]
    v_pk_mul_f32 v[148:149], v[148:149], v[76:77]
    v_pk_mul_f32 v[150:151], v[150:151], v[78:79]
    v_cvt_pk_bf16_f32 v116, v144, v145
    v_cvt_pk_bf16_f32 v117, v146, v147
    v_cvt_pk_bf16_f32 v118, v148, v149
    v_cvt_pk_bf16_f32 v119, v150, v151
    buffer_store_dwordx4 v[116:119], v237, s[24:27], s42 offen offset:2048 sc1
    s_cmp_eq_u32 s101, 0
    s_cbranch_scc1 L_cold_22
L_back_23:
    v_pk_mul_f32 v[128:129], v[80:81], v[80:81]
    v_pk_mul_f32 v[130:131], v[82:83], v[82:83]
    v_pk_mul_f32 v[132:133], v[84:85], v[84:85]
    v_pk_mul_f32 v[134:135], v[86:87], v[86:87]
    v_pk_fma_f32 v[128:129], v[128:129], v[26:27], v[26:27] op_sel:[0,1,0] op_sel_hi:[1,1,0]
    v_pk_fma_f32 v[130:131], v[130:131], v[26:27], v[26:27] op_sel:[0,1,0] op_sel_hi:[1,1,0]
    v_pk_fma_f32 v[132:133], v[132:133], v[26:27], v[26:27] op_sel:[0,1,0] op_sel_hi:[1,1,0]
    v_pk_fma_f32 v[134:135], v[134:135], v[26:27], v[26:27] op_sel:[0,1,0] op_sel_hi:[1,1,0]
    v_pk_mul_f32 v[128:129], v[128:129], v[80:81]
    v_pk_mul_f32 v[130:131], v[130:131], v[82:83]
    v_pk_mul_f32 v[132:133], v[132:133], v[84:85]
    v_pk_mul_f32 v[134:135], v[134:135], v[86:87]
    s_add_u32 s65, s65, 6144
    buffer_load_dwordx4 v249, s[28:31], s65 offen offset:1024 lds
    ds_write_b128 v238, v[160:163] offset:9664
    v_exp_f32 v128, v128
    v_exp_f32 v129, v129
    v_exp_f32 v130, v130
    v_exp_f32 v131, v131
    v_exp_f32 v132, v132
    v_exp_f32 v133, v133
    v_exp_f32 v134, v134
    v_exp_f32 v135, v135
    v_pk_add_f32 v[128:129], v[128:129], 1.0 op_sel_hi:[1,0]
    v_pk_add_f32 v[130:131], v[130:131], 1.0 op_sel_hi:[1,0]
    v_pk_add_f32 v[132:133], v[132:133], 1.0 op_sel_hi:[1,0]
    v_pk_add_f32 v[134:135], v[134:135], 1.0 op_sel_hi:[1,0]
    s_add_u32 s65, s65, 6144
    buffer_load_dwordx4 v249, s[28:31], s65 offen offset:2048 lds
    ds_write_b128 v238, v[168:171] offset:384
    s_waitcnt vmcnt(11)
    s_xor_b32 s63, s48, 0x400
    s_mov_b64 exec, 0x1
    buffer_atomic_swap v31, off, s[24:27], s63 offset:32 sc1
    s_mov_b64 exec, -1
    s_mov_b32 exec_hi, 0
    global_atomic_or v248, v25, v30, s[24:25] sc0 sc1
    s_mov_b64 exec, -1
    v_rcp_f32 v128, v128
    v_rcp_f32 v129, v129
    v_rcp_f32 v130, v130
    v_rcp_f32 v131, v131
    v_rcp_f32 v132, v132
    v_rcp_f32 v133, v133
    v_rcp_f32 v134, v134
    v_rcp_f32 v135, v135
    s_nop 0
    v_pk_mul_f32 v[128:129], v[128:129], v[80:81]
    v_pk_mul_f32 v[130:131], v[130:131], v[82:83]
    v_pk_mul_f32 v[132:133], v[132:133], v[84:85]
    v_pk_mul_f32 v[134:135], v[134:135], v[86:87]
    v_cvt_pk_bf16_f32 v120, v128, v129
    v_cvt_pk_bf16_f32 v121, v130, v131
    v_cvt_pk_bf16_f32 v122, v132, v133
    v_cvt_pk_bf16_f32 v123, v134, v135
    buffer_store_dwordx4 v[120:123], v29, s[24:27], s43 offen offset:2048 sc1
    v_accvgpr_write_b32 a112, v112
    v_accvgpr_write_b32 a113, v113
    v_accvgpr_write_b32 a114, v114
    v_accvgpr_write_b32 a115, v115
    v_accvgpr_write_b32 a116, v116
    v_accvgpr_write_b32 a117, v117
    v_accvgpr_write_b32 a118, v118
    v_accvgpr_write_b32 a119, v119
    s_cmp_eq_u32 s101, 0
    s_cbranch_scc1 L_cold_25
L_back_26:
    v_pk_mul_f32 v[144:145], v[88:89], v[88:89]
    v_pk_mul_f32 v[146:147], v[90:91], v[90:91]
    v_pk_mul_f32 v[148:149], v[92:93], v[92:93]
    v_pk_mul_f32 v[150:151], v[94:95], v[94:95]
    v_pk_fma_f32 v[144:145], v[144:145], v[26:27], v[26:27] op_sel:[0,1,0] op_sel_hi:[1,1,0]
    v_pk_fma_f32 v[146:147], v[146:147], v[26:27], v[26:27] op_sel:[0,1,0] op_sel_hi:[1,1,0]
    v_pk_fma_f32 v[148:149], v[148:149], v[26:27], v[26:27] op_sel:[0,1,0] op_sel_hi:[1,1,0]
    v_pk_fma_f32 v[150:151], v[150:151], v[26:27], v[26:27] op_sel:[0,1,0] op_sel_hi:[1,1,0]
    v_pk_mul_f32 v[144:145], v[144:145], v[88:89]
    v_pk_mul_f32 v[146:147], v[146:147], v[90:91]
    v_pk_mul_f32 v[148:149], v[148:149], v[92:93]
    v_pk_mul_f32 v[150:151], v[150:151], v[94:95]
    s_add_u32 s65, s65, 6144
    buffer_load_dwordx4 v249, s[28:31], s65 offen offset:3072 lds
    ds_write_b128 v238, v[172:175] offset:10688
    v_exp_f32 v144, v144
    v_exp_f32 v145, v145
    v_exp_f32 v146, v146
    v_exp_f32 v147, v147
    v_exp_f32 v148, v148
    v_exp_f32 v149, v149
    v_exp_f32 v150, v150
    v_exp_f32 v151, v151
    v_pk_add_f32 v[144:145], v[144:145], 1.0 op_sel_hi:[1,0]
    v_pk_add_f32 v[146:147], v[146:147], 1.0 op_sel_hi:[1,0]
    v_pk_add_f32 v[148:149], v[148:149], 1.0 op_sel_hi:[1,0]
    v_pk_add_f32 v[150:151], v[150:151], 1.0 op_sel_hi:[1,0]
    s_bfe_u32 s65, s46, 0x40014
    s_mul_i32 s65, s65, 114688
    s_add_u32 m0, s45, 98304
    s_nop 0
    buffer_load_dwordx4 v249, s[28:31], s65 offen offset:0 lds
    ds_write_b128 v238, v[180:183] offset:1408
    v_rcp_f32 v144, v144
    v_rcp_f32 v145, v145
    v_rcp_f32 v146, v146
    v_rcp_f32 v147, v147
    v_rcp_f32 v148, v148
    v_rcp_f32 v149, v149
    v_rcp_f32 v150, v150
    v_rcp_f32 v151, v151
    s_nop 0
    v_pk_mul_f32 v[144:145], v[144:145], v[88:89]
    v_pk_mul_f32 v[146:147], v[146:147], v[90:91]
    v_pk_mul_f32 v[148:149], v[148:149], v[92:93]
    v_pk_mul_f32 v[150:151], v[150:151], v[94:95]
    v_cvt_pk_bf16_f32 v124, v144, v145
    v_cvt_pk_bf16_f32 v125, v146, v147
    v_cvt_pk_bf16_f32 v126, v148, v149
    v_cvt_pk_bf16_f32 v127, v150, v151
    buffer_store_dwordx4 v[124:127], v237, s[24:27], s43 offen offset:2048 sc1
    s_mov_b32 exec_hi, 0
    global_atomic_or v248, v25, v30, s[24:25] sc0 sc1
    s_mov_b64 exec, -1
    s_cmp_lg_u32 s101, 1
    s_cbranch_scc1 L_cold_27
L_back_28:
    s_waitcnt vmcnt(16) lgkmcnt(0)
    s_barrier
    s_add_u32 s65, s65, 6144
    buffer_load_dwordx4 v249, s[28:31], s65 offen offset:1024 lds
    ds_read_b128 v[160:163], v12 offset:0
    ds_read_b64 v[192:193], v13 offset:3584
    ds_read_b64 v[194:195], v13 offset:3592
    ds_read_b128 v[164:167], v12 offset:512
    ds_read_b64 v[196:197], v13 offset:3072
    ds_read_b64 v[198:199], v13 offset:3080
    ds_read_b128 v[168:171], v12 offset:1024
    ds_read_b64 v[200:201], v13 offset:2560
    ds_read_b64 v[202:203], v13 offset:2568
    s_waitcnt lgkmcnt(6)
    v_mfma_f32_16x16x32_bf16 v[32:35], v[160:163], v[192:195], 0
    s_waitcnt lgkmcnt(3)
    ds_read_b128 v[172:175], v12 offset:1536
    ds_read_b64 v[204:205], v13 offset:2048
    v_mfma_f32_16x16x32_bf16 v[36:39], v[160:163], v[196:199], 0
    s_add_u32 s65, s65, 6144
    ds_read_b64 v[206:207], v13 offset:2056
    ds_read_b128 v[176:179], v12 offset:2048
    v_mfma_f32_16x16x32_bf16 v[36:39], v[164:167], v[192:195], v[36:39]
    s_mul_i32 s62, s6, 7
    ds_read_b64 v[208:209], v13 offset:1536
    ds_read_b64 v[210:211], v13 offset:1544
    v_mfma_f32_16x16x32_bf16 v[40:43], v[164:167], v[196:199], 0
    s_waitcnt lgkmcnt(6)
    ds_read_b128 v[180:183], v12 offset:2560
    ds_read_b64 v[212:213], v13 offset:1024
    buffer_load_dwordx4 v249, s[28:31], s65 offen offset:2048 lds
    v_mfma_f32_16x16x32_bf16 v[40:43], v[160:163], v[200:203], v[40:43]
    s_add_u32 s65, s65, 6144
    ds_read_b64 v[214:215], v13 offset:1032
    ds_read_b128 v[184:187], v12 offset:3072
    v_mfma_f32_16x16x32_bf16 v[44:47], v[164:167], v[200:203], 0
    s_add_u32 s62, s62, s7
    ds_read_b64 v[216:217], v13 offset:512
    ds_read_b64 v[218:219], v13 offset:520
    v_mfma_f32_16x16x32_bf16 v[40:43], v[168:171], v[192:195], v[40:43]
    s_lshl_b32 s62, s62, 1
    ds_read_b128 v[188:191], v12 offset:3584
    ds_read_b64 v[220:221], v13 offset:0
    v_mfma_f32_16x16x32_bf16 v[44:47], v[168:171], v[196:199], v[44:47]
    s_add_u32 s62, s62, s60
    ds_read_b64 v[222:223], v13 offset:8
    ds_read_b128 v[96:99], v12 offset:64
    buffer_load_dwordx4 v249, s[28:31], s65 offen offset:3072 lds
    v_mfma_f32_16x16x32_bf16 v[48:51], v[168:171], v[200:203], 0
    s_waitcnt lgkmcnt(13)
    ds_read_b64 v[128:129], v13 offset:3648
    v_lshrrev_b32 v2, 4, v1
    v_mfma_f32_16x16x32_bf16 v[44:47], v[160:163], v[204:207], v[44:47]
    s_lshl_b32 s62, s62, 14
    ds_read_b64 v[130:131], v13 offset:3656
    v_lshl_add_u32 v5, v2, 7, v5
    v_mfma_f32_16x16x32_bf16 v[48:51], v[164:167], v[204:207], v[48:51]
    s_add_u32 s62, s62, s45
    ds_read_b128 v[100:103], v12 offset:576
    s_waitcnt vmcnt(12)
    s_mov_b64 exec, 0x1
    buffer_atomic_swap v31, off, s[24:27], s48 offset:64 sc1
    s_mov_b64 exec, -1
    v_add_u32 v23, 0x200, v5
    v_mfma_f32_16x16x32_bf16 v[52:55], v[168:171], v[204:207], 0
    s_add_u32 s14, s62, 0x3c0000
    ds_read_b64 v[132:133], v13 offset:3136
    v_cmp_ne_u32 vcc, s3, v248
    s_and_b32 s63, vcc_lo, 0x7f
    s_cbranch_scc1 L_cold_31
L_back_32:
    v_lshlrev_b32 v2, 26, v1
    v_lshlrev_b32 v3, 27, v1
    v_and_b32 v2, v2, v3
    v_and_b32 v2, 0x80000000, v2
    v_or_b32 v23, v23, v2
    v_lshlrev_b32 v2, 2, v1
    v_lshlrev_b32 v224, 16, v240
    v_and_b32 v225, 0xffff0000, v240
    v_lshlrev_b32 v226, 16, v241
    v_and_b32 v227, 0xffff0000, v241
    v_lshlrev_b32 v228, 16, v242
    v_and_b32 v229, 0xffff0000, v242
    v_lshlrev_b32 v230, 16, v243
    v_and_b32 v231, 0xffff0000, v243
    v_lshlrev_b32 v232, 16, v244
    v_and_b32 v233, 0xffff0000, v244
    v_lshlrev_b32 v234, 16, v245
    v_and_b32 v235, 0xffff0000, v245
    v_lshlrev_b32 v236, 16, v246
    v_and_b32 v237, 0xffff0000, v246
    v_lshlrev_b32 v238, 16, v247
    v_and_b32 v239, 0xffff0000, v247
    buffer_load_dwordx2 v[240:241], v5, s[24:27], s56 offen sc1
    buffer_load_dwordx2 v[242:243], v23, s[24:27], s56 offen sc1
    v_accvgpr_read_b32 v14, a235
    v_mfma_f32_16x16x32_bf16 v[44:47], v[172:175], v[192:195], v[44:47]
    s_xor_b32 s13, s14, 0x4000
    ds_read_b64 v[134:135], v13 offset:3144
    s_mov_b32 exec_hi, 0
    global_atomic_or v248, v25, v30, s[24:25] sc0 sc1
    s_mov_b64 exec, -1
    ds_read_b64 v[244:245], v14 offset:0
    v_mfma_f32_16x16x32_bf16 v[48:51], v[172:175], v[196:199], v[48:51]
    s_add_u32 s12, s57, 14336
    ds_read_b128 v[104:107], v12 offset:1088
    ds_read_b64 v[246:247], v14 offset:32
    v_mfma_f32_16x16x32_bf16 v[52:55], v[172:175], v[200:203], v[52:55]
    ds_read_b64 v[136:137], v13 offset:2624
    v_accvgpr_read_b32 v16, a233
    v_mfma_f32_16x16x32_bf16 v[56:59], v[172:175], v[204:207], 0
    s_waitcnt lgkmcnt(15)
    ds_read_b64 v[138:139], v13 offset:2632
    buffer_load_dwordx4 a[8:11], v10, s[24:27], s33 offen offset:0 sc1
    v_mfma_f32_16x16x32_bf16 v[48:51], v[160:163], v[208:211], v[48:51]
    ds_read_b128 v[108:111], v12 offset:1600
    v_accvgpr_read_b32 v14, a231
    v_mfma_f32_16x16x32_bf16 v[52:55], v[164:167], v[208:211], v[52:55]
    ds_read_b64 v[140:141], v13 offset:2112
    v_accvgpr_read_b32 v15, a232
    v_mfma_f32_16x16x32_bf16 v[56:59], v[168:171], v[208:211], v[56:59]
    ds_read_b64 v[142:143], v13 offset:2120
    v_accvgpr_read_b32 v18, a244
    v_mfma_f32_16x16x32_bf16 v[60:63], v[172:175], v[208:211], 0
    ds_read_b128 v[112:115], v12 offset:2112
    buffer_load_dwordx4 a[12:15], v11, s[24:27], s33 offen offset:0 sc1
    v_mfma_f32_16x16x32_bf16 v[48:51], v[176:179], v[192:195], v[48:51]
    ds_read_b64 v[144:145], v13 offset:1600
    v_accvgpr_read_b32 v19, a245
    v_mfma_f32_16x16x32_bf16 v[52:55], v[176:179], v[196:199], v[52:55]
    ds_read_b64 v[146:147], v13 offset:1608
    v_accvgpr_read_b32 v20, a246
    v_mfma_f32_16x16x32_bf16 v[56:59], v[176:179], v[200:203], v[56:59]
    ds_read_b128 v[116:119], v12 offset:2624
    v_accvgpr_read_b32 v21, a247
    v_mfma_f32_16x16x32_bf16 v[60:63], v[176:179], v[204:207], v[60:63]
    s_waitcnt lgkmcnt(15)
    ds_read_b64 v[148:149], v13 offset:1088
    buffer_load_dwordx4 a[16:19], v10, s[24:27], s34 offen offset:0 sc1
    v_mfma_f32_16x16x32_bf16 v[52:55], v[160:163], v[212:215], v[52:55]
    ds_read_b64 v[150:151], v13 offset:1096
    ds_read_b64 v[80:81], v16 offset:1536
    v_mfma_f32_16x16x32_bf16 v[56:59], v[164:167], v[212:215], v[56:59]
    ds_read_b128 v[120:123], v12 offset:3136
    ds_read_b64 v[82:83], v16 offset:1024
    v_mfma_f32_16x16x32_bf16 v[60:63], v[168:171], v[212:215], v[60:63]
    ds_read_b64 v[152:153], v13 offset:576
    ds_read_b64 v[84:85], v16 offset:512
    v_mfma_f32_16x16x32_bf16 v[52:55], v[180:183], v[192:195], v[52:55]
    ds_read_b64 v[154:155], v13 offset:584
    buffer_load_dwordx4 a[20:23], v11, s[24:27], s34 offen offset:0 sc1
    v_mfma_f32_16x16x32_bf16 v[56:59], v[180:183], v[196:199], v[56:59]
    ds_read_b128 v[124:127], v12 offset:3648
    ds_read_b64 v[86:87], v16 offset:0
    v_mfma_f32_16x16x32_bf16 v[60:63], v[180:183], v[200:203], v[60:63]
    s_waitcnt lgkmcnt(15)
    ds_read_b64 v[156:157], v13 offset:64
    v_add_u32 v6, 0x10000, v18
    v_mfma_f32_16x16x32_bf16 v[56:59], v[160:163], v[216:219], v[56:59]
    ds_read_b64 v[158:159], v13 offset:72
    s_waitcnt vmcnt(12)
    s_xor_b32 s63, s48, 0x400
    s_mov_b64 exec, 0x1
    buffer_atomic_swap v31, off, s[24:27], s63 offset:96 sc1
    s_mov_b64 exec, -1
    v_add_u32 v7, 0x10000, v19
    v_mfma_f32_16x16x32_bf16 v[60:63], v[164:167], v[216:219], v[60:63]
    buffer_load_dwordx4 a[24:27], v10, s[24:27], s35 offen offset:0 sc1
    v_add_u32 v8, 0x10000, v20
    v_mfma_f32_16x16x32_bf16 v[56:59], v[184:187], v[192:195], v[56:59]
    v_add_u32 v9, 0x10000, v21
    v_accvgpr_read_b32 v16, a234
    v_mfma_f32_16x16x32_bf16 v[60:63], v[184:187], v[196:199], v[60:63]
    s_waitcnt lgkmcnt(15)
    s_waitcnt lgkmcnt(2)
    v_lshlrev_b32 v88, 16, v244
    v_mfma_f32_16x16x32_bf16 v[60:63], v[160:163], v[220:223], v[60:63]
    v_and_b32 v89, 0xffff0000, v244
    v_lshlrev_b32 v90, 16, v245
    v_mfma_f32_16x16x32_bf16 v[60:63], v[188:191], v[192:195], v[60:63]
    buffer_load_dwordx4 a[28:31], v11, s[24:27], s35 offen offset:0 sc1
    v_and_b32 v91, 0xffff0000, v245
    v_mfma_f32_16x16x32_bf16 v[32:35], v[96:99], v[128:131], v[32:35]
    ds_read_b128 v[160:163], v12 offset:128
    v_lshlrev_b32 v92, 16, v246
    v_mfma_f32_16x16x32_bf16 v[36:39], v[96:99], v[132:135], v[36:39]
    ds_read_b64 v[192:193], v13 offset:3712
    v_and_b32 v93, 0xffff0000, v246
    v_mfma_f32_16x16x32_bf16 v[36:39], v[100:103], v[128:131], v[36:39]
    ds_read_b64 v[194:195], v13 offset:3720
    v_lshlrev_b32 v94, 16, v247
    v_mfma_f32_16x16x32_bf16 v[40:43], v[100:103], v[132:135], v[40:43]
    ds_read_b128 v[164:167], v12 offset:640
    buffer_load_dwordx4 a[32:35], v10, s[24:27], s36 offen offset:0 sc1
    v_mfma_f32_16x16x32_bf16 v[40:43], v[96:99], v[136:139], v[40:43]
    ds_read_b64 v[196:197], v13 offset:3200
    v_and_b32 v95, 0xffff0000, v247
    v_mfma_f32_16x16x32_bf16 v[44:47], v[100:103], v[136:139], v[44:47]
    ds_read_b64 v[198:199], v13 offset:3208
    v_and_b32 v64, 0xffff0000, v81
    v_mfma_f32_16x16x32_bf16 v[40:43], v[104:107], v[128:131], v[40:43]
    ds_read_b128 v[168:171], v12 offset:1152
    v_lshlrev_b32 v65, 16, v81
    v_mfma_f32_16x16x32_bf16 v[44:47], v[104:107], v[132:135], v[44:47]
    ds_read_b64 v[200:201], v13 offset:2688
    buffer_load_dwordx4 a[36:39], v11, s[24:27], s36 offen offset:0 sc1
    v_mfma_f32_16x16x32_bf16 v[48:51], v[104:107], v[136:139], v[48:51]
    ds_read_b64 v[202:203], v13 offset:2696
    v_and_b32 v66, 0xffff0000, v80
    v_mfma_f32_16x16x32_bf16 v[44:47], v[96:99], v[140:143], v[44:47]
    ds_read_b128 v[172:175], v12 offset:1664
    v_lshlrev_b32 v67, 16, v80
    v_mfma_f32_16x16x32_bf16 v[48:51], v[100:103], v[140:143], v[48:51]
    ds_read_b64 v[204:205], v13 offset:2176
    v_mul_f32 v64, s44, v64
L_stub2:
    s_cbranch_execz L_stub3
    s_nop 0
    v_mfma_f32_16x16x32_bf16 v[52:55], v[104:107], v[140:143], v[52:55]
    ds_read_b64 v[206:207], v13 offset:2184
    buffer_load_dwordx4 a[40:43], v10, s[24:27], s37 offen offset:0 sc1
    v_mfma_f32_16x16x32_bf16 v[44:47], v[108:111], v[128:131], v[44:47]
    ds_read_b128 v[176:179], v12 offset:2176
    v_mul_f32 v65, s44, v65
    v_mfma_f32_16x16x32_bf16 v[48:51], v[108:111], v[132:135], v[48:51]
    ds_read_b64 v[208:209], v13 offset:1664
    v_mul_f32 v66, s44, v66
    v_mfma_f32_16x16x32_bf16 v[52:55], v[108:111], v[136:139], v[52:55]
    ds_read_b64 v[210:211], v13 offset:1672
    v_mul_f32 v67, s44, v67
    v_mfma_f32_16x16x32_bf16 v[56:59], v[108:111], v[140:143], v[56:59]
    ds_read_b128 v[180:183], v12 offset:2688
    buffer_load_dwordx4 a[44:47], v11, s[24:27], s37 offen offset:0 sc1
    v_mfma_f32_16x16x32_bf16 v[48:51], v[96:99], v[144:147], v[48:51]
    ds_read_b64 v[212:213], v13 offset:1152
    v_and_b32 v68, 0xffff0000, v83
    v_mfma_f32_16x16x32_bf16 v[52:55], v[100:103], v[144:147], v[52:55]
    ds_read_b64 v[214:215], v13 offset:1160
    v_lshlrev_b32 v69, 16, v83
    v_mfma_f32_16x16x32_bf16 v[56:59], v[104:107], v[144:147], v[56:59]
    ds_read_b128 v[184:187], v12 offset:3200
    v_and_b32 v70, 0xffff0000, v82
    v_mfma_f32_16x16x32_bf16 v[60:63], v[108:111], v[144:147], v[60:63]
    ds_read_b64 v[216:217], v13 offset:640
    buffer_load_dwordx4 a[48:51], v10, s[24:27], s38 offen offset:0 sc1
    v_mfma_f32_16x16x32_bf16 v[48:51], v[112:115], v[128:131], v[48:51]
    ds_read_b64 v[218:219], v13 offset:648
    v_lshlrev_b32 v71, 16, v82
    v_mfma_f32_16x16x32_bf16 v[52:55], v[112:115], v[132:135], v[52:55]
    ds_read_b128 v[188:191], v12 offset:3712
    v_mul_f32 v68, s44, v68
    v_mfma_f32_16x16x32_bf16 v[56:59], v[112:115], v[136:139], v[56:59]
    ds_read_b64 v[220:221], v13 offset:128
    v_mul_f32 v69, s44, v69
    v_mfma_f32_16x16x32_bf16 v[60:63], v[112:115], v[140:143], v[60:63]
    ds_read_b64 v[222:223], v13 offset:136
    buffer_load_dwordx4 a[52:55], v11, s[24:27], s38 offen offset:0 sc1
    v_mfma_f32_16x16x32_bf16 v[52:55], v[96:99], v[148:151], v[52:55]
    v_mul_f32 v70, s44, v70
    v_mul_f32 v71, s44, v71
    v_mfma_f32_16x16x32_bf16 v[56:59], v[100:103], v[148:151], v[56:59]
    v_and_b32 v72, 0xffff0000, v85
    v_lshlrev_b32 v73, 16, v85
    v_mfma_f32_16x16x32_bf16 v[60:63], v[104:107], v[148:151], v[60:63]
    v_cmp_ne_u32 vcc, s3, v248
    s_and_b32 s63, vcc_lo, 0x7f00
    s_cbranch_scc1 L_cold_34
L_back_35:
    v_and_b32 v74, 0xffff0000, v84
    v_lshlrev_b32 v75, 16, v84
    v_mfma_f32_16x16x32_bf16 v[52:55], v[116:119], v[128:131], v[52:55]
    buffer_load_dwordx4 a[56:59], v0, s[24:27], s32 offen offset:0 sc1
    v_mul_f32 v72, s44, v72
    v_mfma_f32_16x16x32_bf16 v[56:59], v[116:119], v[132:135], v[56:59]
    s_mov_b32 exec_hi, 0
    global_atomic_or v248, v25, v30, s[24:25] sc0 sc1
    s_mov_b64 exec, -1
    v_mul_f32 v73, s44, v73
    v_mul_f32 v74, s44, v74
    v_mfma_f32_16x16x32_bf16 v[60:63], v[116:119], v[136:139], v[60:63]
    v_mul_f32 v75, s44, v75
    v_and_b32 v76, 0xffff0000, v87
    v_mfma_f32_16x16x32_bf16 v[56:59], v[96:99], v[152:155], v[56:59]
    v_lshlrev_b32 v77, 16, v87
    v_and_b32 v78, 0xffff0000, v86
    v_mfma_f32_16x16x32_bf16 v[60:63], v[100:103], v[152:155], v[60:63]
    buffer_load_dwordx4 a[60:63], v22, s[24:27], s32 offen offset:0 sc1
    v_lshlrev_b32 v79, 16, v86
    v_mfma_f32_16x16x32_bf16 v[56:59], v[120:123], v[128:131], v[56:59]
    v_mul_f32 v76, s44, v76
    v_mul_f32 v77, s44, v77
    v_mfma_f32_16x16x32_bf16 v[60:63], v[120:123], v[132:135], v[60:63]
    s_waitcnt lgkmcnt(15)
    v_mul_f32 v78, s44, v78
    v_mul_f32 v79, s44, v79
    v_mfma_f32_16x16x32_bf16 v[60:63], v[96:99], v[156:159], v[60:63]
    v_mfma_f32_16x16x32_bf16 v[60:63], v[124:127], v[128:131], v[60:63]
    s_waitcnt lgkmcnt(15)
    buffer_load_dwordx4 a[64:67], v0, s[24:27], s33 offen offset:0 sc1
    v_mfma_f32_16x16x32_bf16 v[32:35], v[160:163], v[192:195], v[32:35]
    s_waitcnt lgkmcnt(15)
    ds_read_b128 v[96:99], v12 offset:192
    v_mfma_f32_16x16x32_bf16 v[36:39], v[160:163], v[196:199], v[36:39]
    ds_read_b64 v[128:129], v13 offset:3776
    v_mfma_f32_16x16x32_bf16 v[36:39], v[164:167], v[192:195], v[36:39]
    ds_read_b64 v[130:131], v13 offset:3784
    v_mfma_f32_16x16x32_bf16 v[40:43], v[164:167], v[196:199], v[40:43]
    s_waitcnt lgkmcnt(15)
    ds_read_b128 v[100:103], v12 offset:704
    buffer_load_dwordx4 a[68:71], v22, s[24:27], s33 offen offset:0 sc1
    v_mfma_f32_16x16x32_bf16 v[40:43], v[160:163], v[200:203], v[40:43]
    ds_read_b64 v[132:133], v13 offset:3264
    v_mfma_f32_16x16x32_bf16 v[44:47], v[164:167], v[200:203], v[44:47]
    ds_read_b64 v[134:135], v13 offset:3272
    v_mfma_f32_16x16x32_bf16 v[40:43], v[168:171], v[192:195], v[40:43]
    ds_read_b128 v[104:107], v12 offset:1216
    v_mfma_f32_16x16x32_bf16 v[44:47], v[168:171], v[196:199], v[44:47]
    ds_read_b64 v[136:137], v13 offset:2752
    buffer_load_dwordx4 a[72:75], v0, s[24:27], s34 offen offset:0 sc1
    v_mfma_f32_16x16x32_bf16 v[48:51], v[168:171], v[200:203], v[48:51]
    s_waitcnt lgkmcnt(15)
    ds_read_b64 v[138:139], v13 offset:2760
    v_mfma_f32_16x16x32_bf16 v[44:47], v[160:163], v[204:207], v[44:47]
    ds_read_b128 v[108:111], v12 offset:1728
    v_mfma_f32_16x16x32_bf16 v[48:51], v[164:167], v[204:207], v[48:51]
    ds_read_b64 v[140:141], v13 offset:2240
    v_mfma_f32_16x16x32_bf16 v[52:55], v[168:171], v[204:207], v[52:55]
    ds_read_b64 v[142:143], v13 offset:2248
    buffer_load_dwordx4 a[76:79], v22, s[24:27], s34 offen offset:0 sc1
    v_mfma_f32_16x16x32_bf16 v[44:47], v[172:175], v[192:195], v[44:47]
    ds_read_b128 v[112:115], v12 offset:2240
    v_mfma_f32_16x16x32_bf16 v[48:51], v[172:175], v[196:199], v[48:51]
    ds_read_b64 v[144:145], v13 offset:1728
    v_mfma_f32_16x16x32_bf16 v[52:55], v[172:175], v[200:203], v[52:55]
    ds_read_b64 v[146:147], v13 offset:1736
    v_mfma_f32_16x16x32_bf16 v[56:59], v[172:175], v[204:207], v[56:59]
    s_waitcnt lgkmcnt(15)
    ds_read_b128 v[116:119], v12 offset:2752
    buffer_load_dwordx4 a[80:83], v0, s[24:27], s35 offen offset:0 sc1
    v_mfma_f32_16x16x32_bf16 v[48:51], v[160:163], v[208:211], v[48:51]
    ds_read_b64 v[148:149], v13 offset:1216
    s_waitcnt vmcnt(22)
    v_add_f32 v240, v240, v242
    v_mfma_f32_16x16x32_bf16 v[52:55], v[164:167], v[208:211], v[52:55]
    ds_read_b64 v[150:151], v13 offset:1224
    v_add_f32 v241, v241, v243
    v_mfma_f32_16x16x32_bf16 v[56:59], v[168:171], v[208:211], v[56:59]
    ds_read_b128 v[120:123], v12 offset:3264
    v_mov_b32 v242, v240
    v_mfma_f32_16x16x32_bf16 v[60:63], v[172:175], v[208:211], v[60:63]
    ds_read_b64 v[152:153], v13 offset:704
    buffer_load_dwordx4 a[84:87], v22, s[24:27], s35 offen offset:0 sc1
    v_mfma_f32_16x16x32_bf16 v[48:51], v[176:179], v[192:195], v[48:51]
    ds_read_b64 v[154:155], v13 offset:712
    v_mov_b32 v243, v241
    v_mfma_f32_16x16x32_bf16 v[52:55], v[176:179], v[196:199], v[52:55]
    ds_read_b128 v[124:127], v12 offset:3776
    v_permlane32_swap_b32 v240, v242
    v_mfma_f32_16x16x32_bf16 v[56:59], v[176:179], v[200:203], v[56:59]
    ds_read_b64 v[156:157], v13 offset:192
    v_permlane32_swap_b32 v241, v243
    v_mfma_f32_16x16x32_bf16 v[60:63], v[176:179], v[204:207], v[60:63]
    s_waitcnt lgkmcnt(15)
    ds_read_b64 v[158:159], v13 offset:200
    buffer_load_dwordx4 a[88:91], v0, s[24:27], s36 offen offset:0 sc1
    v_mfma_f32_16x16x32_bf16 v[52:55], v[160:163], v[212:215], v[52:55]
    v_add_f32 v240, v240, v242
    v_add_f32 v241, v241, v243
    v_mfma_f32_16x16x32_bf16 v[56:59], v[164:167], v[212:215], v[56:59]
    v_mov_b32 v242, v240
    v_mov_b32 v243, v241
    v_mfma_f32_16x16x32_bf16 v[60:63], v[168:171], v[212:215], v[60:63]
    v_permlane16_swap_b32 v240, v242
    v_permlane16_swap_b32 v241, v243
    v_mfma_f32_16x16x32_bf16 v[52:55], v[180:183], v[192:195], v[52:55]
    buffer_load_dwordx4 a[92:95], v22, s[24:27], s36 offen offset:0 sc1
    v_add_f32 v240, v240, v242
    v_mfma_f32_16x16x32_bf16 v[56:59], v[180:183], v[196:199], v[56:59]
    v_add_f32 v241, v241, v243
    v_mul_f32 v240, 0xbfb8aa3b, v240
    v_mfma_f32_16x16x32_bf16 v[60:63], v[180:183], v[200:203], v[60:63]
    s_waitcnt lgkmcnt(15)
    v_mul_f32 v241, 0xbfb8aa3b, v241
    v_exp_f32 v240, v240
    v_mfma_f32_16x16x32_bf16 v[56:59], v[160:163], v[216:219], v[56:59]
    v_exp_f32 v241, v241
    v_add_f32 v240, 1.0, v240
    v_mfma_f32_16x16x32_bf16 v[60:63], v[164:167], v[216:219], v[60:63]
    buffer_load_dwordx4 a[96:99], v0, s[24:27], s37 offen offset:0 sc1
    v_add_f32 v241, 1.0, v241
    v_mfma_f32_16x16x32_bf16 v[56:59], v[184:187], v[192:195], v[56:59]
    v_rcp_f32 v240, v240
    v_rcp_f32 v241, v241
    v_mfma_f32_16x16x32_bf16 v[60:63], v[184:187], v[196:199], v[60:63]
    s_waitcnt lgkmcnt(15)
    v_sub_f32 v242, 1.0, v240
    v_sub_f32 v243, 1.0, v241
    v_mfma_f32_16x16x32_bf16 v[60:63], v[160:163], v[220:223], v[60:63]
    v_mul_f32 v224, v224, v240
    v_mul_f32 v225, v225, v240
    v_mfma_f32_16x16x32_bf16 v[60:63], v[188:191], v[192:195], v[60:63]
    s_waitcnt lgkmcnt(15)
    buffer_load_dwordx4 a[100:103], v22, s[24:27], s37 offen offset:0 sc1
    v_mul_f32 v226, v226, v240
    v_mfma_f32_16x16x32_bf16 v[48:51], v[104:107], v[136:139], v[48:51]
    s_waitcnt lgkmcnt(12)
    v_mul_f32 v227, v227, v240
    v_mul_f32 v228, v228, v240
    v_mfma_f32_16x16x32_bf16 v[48:51], v[100:103], v[140:143], v[48:51]
    v_mul_f32 v229, v229, v240
    v_mul_f32 v230, v230, v240
    v_mfma_f32_16x16x32_bf16 v[48:51], v[108:111], v[132:135], v[48:51]
    v_mul_f32 v231, v231, v240
    v_mul_f32 v232, v232, v241
    v_mfma_f32_16x16x32_bf16 v[52:55], v[104:107], v[140:143], v[52:55]
    buffer_load_dwordx4 a[104:107], v0, s[24:27], s38 offen offset:0 sc1
    v_mul_f32 v233, v233, v241
    v_mfma_f32_16x16x32_bf16 v[52:55], v[108:111], v[136:139], v[52:55]
    s_waitcnt lgkmcnt(0)
    s_barrier
    ds_read_b64_tr_b16 v[160:161], v18 offset:0
    ds_read_b64_tr_b16 v[162:163], v18 offset:2048
    v_mfma_f32_16x16x32_bf16 v[56:59], v[108:111], v[140:143], v[56:59]
    ds_read_b64_tr_b16 v[164:165], v19 offset:0
    ds_read_b64_tr_b16 v[166:167], v19 offset:2048
    v_mfma_f32_16x16x32_bf16 v[48:51], v[96:99], v[144:147], v[48:51]
    ds_read_b64_tr_b16 v[168:169], v18 offset:16384
    ds_read_b64_tr_b16 v[170:171], v18 offset:18432
    v_mfma_f32_16x16x32_bf16 v[48:51], v[112:115], v[128:131], v[48:51]
    buffer_load_dwordx4 a[108:111], v22, s[24:27], s38 offen offset:0 sc1
    ds_read_b64_tr_b16 v[172:173], v19 offset:16384
    v_mfma_f32_16x16x32_bf16 v[52:55], v[100:103], v[144:147], v[52:55]
    ds_read_b64_tr_b16 v[174:175], v19 offset:18432
    ds_read_b64_tr_b16 v[176:177], v18 offset:32768
    v_mfma_f32_16x16x32_bf16 v[52:55], v[112:115], v[132:135], v[52:55]
    ds_read_b64_tr_b16 v[178:179], v18 offset:34816
    ds_read_b64_tr_b16 v[180:181], v19 offset:32768
    v_mfma_f32_16x16x32_bf16 v[56:59], v[104:107], v[144:147], v[56:59]
    v_cmp_ne_u32 vcc, s3, v248
    s_and_b32 s63, vcc_lo, 0x7f0000
    s_cbranch_scc1 L_cold_37
L_back_38:
    ds_read_b64_tr_b16 v[182:183], v19 offset:34816
    v_mul_f32 v234, v234, v241
    v_mfma_f32_16x16x32_bf16 v[56:59], v[112:115], v[136:139], v[56:59]
    buffer_load_dwordx4 a[120:123], v10, s[24:27], s33 offen offset:2048 sc1
    v_mul_f32 v235, v235, v241
    v_mfma_f32_16x16x32_bf16 v[52:55], v[96:99], v[148:151], v[52:55]
    s_mov_b32 exec_hi, 0
    global_atomic_or v248, v25, v30, s[24:25] sc0 sc1
    s_mov_b64 exec, -1
    v_mul_f32 v236, v236, v241
    v_mul_f32 v237, v237, v241
    v_mfma_f32_16x16x32_bf16 v[52:55], v[116:119], v[128:131], v[52:55]
    v_mul_f32 v238, v238, v241
    v_mul_f32 v239, v239, v241
    v_mfma_f32_16x16x32_bf16 v[56:59], v[100:103], v[148:151], v[56:59]
    v_mfma_f32_16x16x32_bf16 v[56:59], v[116:119], v[132:135], v[56:59]
    buffer_load_dwordx4 a[124:127], v11, s[24:27], s33 offen offset:2048 sc1
    v_mfma_f32_16x16x32_bf16 v[56:59], v[96:99], v[152:155], v[56:59]
    s_cmp_lg_u32 s53, 0
    s_cbranch_scc1 L_cv_40
    v_mfma_f32_16x16x32_bf16 v[56:59], v[120:123], v[128:131], v[56:59]
    v_add_f32 v44, v44, v76
    v_add_f32 v45, v45, v77
    v_mfma_f32_16x16x32_bf16 v[60:63], v[96:99], v[156:159], v[60:63]
    v_add_f32 v46, v46, v78
    v_add_f32 v47, v47, v79
    v_mfma_f32_16x16x32_bf16 v[60:63], v[100:103], v[152:155], v[60:63]
    buffer_load_dwordx4 a[128:131], v10, s[24:27], s34 offen offset:2048 sc1
    v_add_f32 v40, v40, v72
    v_mfma_f32_16x16x32_bf16 v[60:63], v[104:107], v[148:151], v[60:63]
    ds_write_b128 v14, v[48:51] offset:0
    v_add_f32 v41, v41, v73
    v_mfma_f32_16x16x32_bf16 v[60:63], v[108:111], v[144:147], v[60:63]
    v_add_f32 v42, v42, v74
    v_add_f32 v43, v43, v75
    v_mfma_f32_16x16x32_bf16 v[60:63], v[112:115], v[140:143], v[60:63]
    v_add_f32 v36, v36, v68
    v_add_f32 v37, v37, v69
    v_mfma_f32_16x16x32_bf16 v[60:63], v[116:119], v[136:139], v[60:63]
    ds_write_b128 v14, v[52:55] offset:1024
    buffer_load_dwordx4 a[132:135], v11, s[24:27], s34 offen offset:2048 sc1
    v_mfma_f32_16x16x32_bf16 v[60:63], v[120:123], v[132:135], v[60:63]
    v_add_f32 v38, v38, v70
    v_add_f32 v39, v39, v71
    v_mfma_f32_16x16x32_bf16 v[60:63], v[124:127], v[128:131], v[60:63]
    v_add_f32 v32, v32, v64
    v_add_f32 v33, v33, v65
    v_mfma_f32_16x16x32_bf16 v[44:47], v[96:99], v[140:143], v[44:47]
    ds_write_b128 v14, v[56:59] offset:2048
    v_add_f32 v34, v34, v66
    v_mfma_f32_16x16x32_bf16 v[44:47], v[100:103], v[136:139], v[44:47]
    buffer_load_dwordx4 a[136:139], v10, s[24:27], s35 offen offset:2048 sc1
    v_add_f32 v35, v35, v67
    v_mfma_f32_16x16x32_bf16 v[44:47], v[104:107], v[132:135], v[44:47]
    v_mfma_f32_16x16x32_bf16 v[44:47], v[108:111], v[128:131], v[44:47]
    ds_write_b128 v14, v[60:63] offset:3072
    v_mfma_f32_16x16x32_bf16 v[40:43], v[96:99], v[136:139], v[40:43]
    v_mfma_f32_16x16x32_bf16 v[40:43], v[100:103], v[132:135], v[40:43]
    buffer_load_dwordx4 a[140:143], v11, s[24:27], s35 offen offset:2048 sc1
    v_mfma_f32_16x16x32_bf16 v[40:43], v[104:107], v[128:131], v[40:43]
    s_waitcnt lgkmcnt(0)
    s_barrier
    ds_read_b128 v[64:67], v15 offset:0
    v_mfma_f32_16x16x32_bf16 v[36:39], v[96:99], v[132:135], v[36:39]
    ds_read_b128 v[68:71], v15 offset:1024
    v_mfma_f32_16x16x32_bf16 v[36:39], v[100:103], v[128:131], v[36:39]
    ds_read_b128 v[72:75], v15 offset:2048
    v_mfma_f32_16x16x32_bf16 v[32:35], v[96:99], v[128:131], v[32:35]
    ds_read_b128 v[76:79], v15 offset:3072
    buffer_load_dwordx4 a[144:147], v10, s[24:27], s36 offen offset:2048 sc1
    s_branch L_cv_41
L_cv_40:
    v_mfma_f32_16x16x32_bf16 v[32:35], v[96:99], v[128:131], v[32:35]
    v_add_f32 v60, v60, v76
    v_add_f32 v61, v61, v77
    v_mfma_f32_16x16x32_bf16 v[36:39], v[96:99], v[132:135], v[36:39]
    v_add_f32 v62, v62, v78
    v_add_f32 v63, v63, v79
    v_mfma_f32_16x16x32_bf16 v[36:39], v[100:103], v[128:131], v[36:39]
    buffer_load_dwordx4 a[128:131], v10, s[24:27], s34 offen offset:2048 sc1
    v_add_f32 v56, v56, v72
    v_mfma_f32_16x16x32_bf16 v[40:43], v[96:99], v[136:139], v[40:43]
    ds_write_b128 v14, v[32:35] offset:0
    v_add_f32 v57, v57, v73
    v_mfma_f32_16x16x32_bf16 v[40:43], v[100:103], v[132:135], v[40:43]
    v_add_f32 v58, v58, v74
    v_add_f32 v59, v59, v75
    v_mfma_f32_16x16x32_bf16 v[40:43], v[104:107], v[128:131], v[40:43]
    v_add_f32 v48, v48, v64
    v_add_f32 v49, v49, v65
    v_mfma_f32_16x16x32_bf16 v[44:47], v[96:99], v[140:143], v[44:47]
    ds_write_b128 v14, v[36:39] offset:1024
    buffer_load_dwordx4 a[132:135], v11, s[24:27], s34 offen offset:2048 sc1
    v_mfma_f32_16x16x32_bf16 v[44:47], v[100:103], v[136:139], v[44:47]
    v_add_f32 v50, v50, v66
    v_add_f32 v51, v51, v67
    v_mfma_f32_16x16x32_bf16 v[44:47], v[104:107], v[132:135], v[44:47]
    v_add_f32 v52, v52, v68
    v_add_f32 v53, v53, v69
    v_mfma_f32_16x16x32_bf16 v[44:47], v[108:111], v[128:131], v[44:47]
    ds_write_b128 v14, v[40:43] offset:2048
    v_add_f32 v54, v54, v70
    v_mfma_f32_16x16x32_bf16 v[56:59], v[120:123], v[128:131], v[56:59]
    buffer_load_dwordx4 a[136:139], v10, s[24:27], s35 offen offset:2048 sc1
    v_add_f32 v55, v55, v71
    v_mfma_f32_16x16x32_bf16 v[60:63], v[96:99], v[156:159], v[60:63]
    v_mfma_f32_16x16x32_bf16 v[60:63], v[100:103], v[152:155], v[60:63]
    s_nop 0
    ds_write_b128 v14, v[44:47] offset:3072
    v_mfma_f32_16x16x32_bf16 v[60:63], v[104:107], v[148:151], v[60:63]
    v_mfma_f32_16x16x32_bf16 v[60:63], v[108:111], v[144:147], v[60:63]
    buffer_load_dwordx4 a[140:143], v11, s[24:27], s35 offen offset:2048 sc1
    v_mfma_f32_16x16x32_bf16 v[60:63], v[112:115], v[140:143], v[60:63]
    s_waitcnt lgkmcnt(0)
    s_barrier
    ds_read_b128 v[64:67], v15 offset:0
    v_mfma_f32_16x16x32_bf16 v[60:63], v[116:119], v[136:139], v[60:63]
    ds_read_b128 v[68:71], v15 offset:1024
    v_mfma_f32_16x16x32_bf16 v[60:63], v[120:123], v[132:135], v[60:63]
    ds_read_b128 v[72:75], v15 offset:2048
    v_mfma_f32_16x16x32_bf16 v[60:63], v[124:127], v[128:131], v[60:63]
    ds_read_b128 v[76:79], v15 offset:3072
    buffer_load_dwordx4 a[144:147], v10, s[24:27], s36 offen offset:2048 sc1
L_cv_41:
    v_mfma_f32_16x16x32_bf16 v[192:195], v[160:163], a[0:3], 0
    ds_read_b64_tr_b16 v[184:185], v18 offset:49152
    v_mfma_f32_16x16x32_bf16 v[200:203], v[160:163], a[4:7], 0
    ds_read_b64_tr_b16 v[186:187], v18 offset:51200
    buffer_load_dwordx4 a[148:151], v11, s[24:27], s36 offen offset:2048 sc1
    v_mfma_f32_16x16x32_bf16 v[196:199], v[164:167], a[0:3], 0
    ds_read_b64_tr_b16 v[188:189], v19 offset:49152
    v_mfma_f32_16x16x32_bf16 v[204:207], v[164:167], a[4:7], 0
    s_waitcnt vmcnt(35)
    ds_read_b64_tr_b16 v[190:191], v19 offset:51200
    s_waitcnt lgkmcnt(4)
    s_cmp_lg_u32 s53, 0
    s_cbranch_scc1 L_cv_42
    v_pk_add_f32 v[64:65], v[64:65], v[32:33]
    v_pk_add_f32 v[66:67], v[66:67], v[34:35]
    v_pk_add_f32 v[68:69], v[68:69], v[36:37]
    v_pk_add_f32 v[70:71], v[70:71], v[38:39]
    v_pk_add_f32 v[72:73], v[72:73], v[40:41]
    v_pk_add_f32 v[74:75], v[74:75], v[42:43]
    v_pk_add_f32 v[76:77], v[76:77], v[44:45]
    v_pk_add_f32 v[78:79], v[78:79], v[46:47]
    s_branch L_cv_43
L_cv_42:
    v_pk_add_f32 v[64:65], v[64:65], v[48:49]
    v_pk_add_f32 v[66:67], v[66:67], v[50:51]
    v_pk_add_f32 v[68:69], v[68:69], v[52:53]
    v_pk_add_f32 v[70:71], v[70:71], v[54:55]
    v_pk_add_f32 v[72:73], v[72:73], v[56:57]
    v_pk_add_f32 v[74:75], v[74:75], v[58:59]
    v_pk_add_f32 v[76:77], v[76:77], v[60:61]
    v_pk_add_f32 v[78:79], v[78:79], v[62:63]
L_cv_43:
    v_mfma_f32_16x16x32_bf16 v[192:195], v[168:171], a[8:11], v[192:195]
    ds_read_b64_tr_b16 v[160:161], v6 offset:0
    v_xor_b32 v18, 0x2000, v18
    v_xor_b32 v19, 0x2000, v19
    v_mfma_f32_16x16x32_bf16 v[200:203], v[168:171], a[12:15], v[200:203]
    ds_read_b64_tr_b16 v[162:163], v6 offset:2048
    buffer_load_dwordx4 a[152:155], v10, s[24:27], s37 offen offset:2048 sc1
    v_cvt_pk_bf16_f32 v80, v64, v65
    v_mfma_f32_16x16x32_bf16 v[196:199], v[172:175], a[8:11], v[196:199]
    ds_read_b64_tr_b16 v[164:165], v7 offset:0
    v_cvt_pk_bf16_f32 v81, v66, v67
    buffer_store_dwordx2 v[80:81], v16, s[24:27], s49 offen offset:0 sc1
    v_mfma_f32_16x16x32_bf16 v[204:207], v[172:175], a[12:15], v[204:207]
    s_waitcnt vmcnt(35)
    ds_read_b64_tr_b16 v[166:167], v7 offset:2048
    v_cvt_pk_bf16_f32 v82, v68, v69
    v_cvt_pk_bf16_f32 v83, v70, v71
    v_mfma_f32_16x16x32_bf16 v[192:195], v[176:179], a[16:19], v[192:195]
    ds_read_b64_tr_b16 v[168:169], v6 offset:16384
    buffer_store_dwordx2 v[82:83], v16, s[24:27], s49 offen offset:512 sc1
    v_cvt_pk_bf16_f32 v84, v72, v73
    v_mfma_f32_16x16x32_bf16 v[200:203], v[176:179], a[20:23], v[200:203]
    ds_read_b64_tr_b16 v[170:171], v6 offset:18432
    buffer_load_dwordx4 a[156:159], v11, s[24:27], s37 offen offset:2048 sc1
    v_cvt_pk_bf16_f32 v85, v74, v75
    v_mfma_f32_16x16x32_bf16 v[196:199], v[180:183], a[16:19], v[196:199]
    ds_read_b64_tr_b16 v[172:173], v7 offset:16384
    buffer_store_dwordx2 v[84:85], v16, s[24:27], s49 offen offset:1024 sc1
    v_cvt_pk_bf16_f32 v86, v76, v77
    v_mfma_f32_16x16x32_bf16 v[204:207], v[180:183], a[20:23], v[204:207]
    s_waitcnt vmcnt(35) lgkmcnt(7)
    ds_read_b64_tr_b16 v[174:175], v7 offset:18432
    v_cvt_pk_bf16_f32 v87, v78, v79
    buffer_store_dwordx2 v[86:87], v16, s[24:27], s49 offen offset:1536 sc1
    v_mfma_f32_16x16x32_bf16 v[192:195], v[184:187], a[24:27], v[192:195]
    ds_read_b64_tr_b16 v[176:177], v6 offset:32768
    v_mfma_f32_16x16x32_bf16 v[200:203], v[184:187], a[28:31], v[200:203]
    ds_read_b64_tr_b16 v[178:179], v6 offset:34816
    buffer_load_dwordx4 a[160:163], v10, s[24:27], s38 offen offset:2048 sc1
    v_mfma_f32_16x16x32_bf16 v[196:199], v[188:191], a[24:27], v[196:199]
    ds_read_b64_tr_b16 v[180:181], v7 offset:32768
    v_accvgpr_read_b32 v13, a240
    v_mfma_f32_16x16x32_bf16 v[204:207], v[188:191], a[28:31], v[204:207]
    s_waitcnt vmcnt(35) lgkmcnt(7)
    ds_read_b64_tr_b16 v[182:183], v7 offset:34816
    v_lshlrev_b32 v12, 10, v1
    v_mfma_f32_16x16x32_bf16 v[192:195], v[160:163], a[32:35], v[192:195]
    ds_read_b64_tr_b16 v[184:185], v18 offset:0
    v_xor_b32 v6, 0x2000, v6
    v_mfma_f32_16x16x32_bf16 v[200:203], v[160:163], a[36:39], v[200:203]
    ds_read_b64_tr_b16 v[186:187], v18 offset:2048
    buffer_load_dwordx4 a[164:167], v11, s[24:27], s38 offen offset:2048 sc1
    v_mfma_f32_16x16x32_bf16 v[196:199], v[164:167], a[32:35], v[196:199]
    ds_read_b64_tr_b16 v[188:189], v19 offset:0
    v_xor_b32 v7, 0x2000, v7
    v_mfma_f32_16x16x32_bf16 v[204:207], v[164:167], a[36:39], v[204:207]
    s_waitcnt vmcnt(34) lgkmcnt(7)
    ds_read_b64_tr_b16 v[190:191], v19 offset:2048
    v_accvgpr_read_b32 v23, a237
    v_cmp_ne_u32 vcc, s3, v248
    s_and_b32 s63, vcc_lo, 0x7f000000
    s_cbranch_scc1 L_cold_44
L_back_45:
    v_mfma_f32_16x16x32_bf16 v[192:195], v[168:171], a[40:43], v[192:195]
    ds_read_b64_tr_b16 v[160:161], v18 offset:16384
    v_accvgpr_read_b32 v14, a241
    v_mfma_f32_16x16x32_bf16 v[200:203], v[168:171], a[44:47], v[200:203]
    ds_read_b64_tr_b16 v[162:163], v18 offset:18432
    buffer_load_dwordx4 a[168:171], v0, s[24:27], s32 offen offset:2048 sc1
    v_mfma_f32_16x16x32_bf16 v[196:199], v[172:175], a[40:43], v[196:199]
    ds_read_b64_tr_b16 v[164:165], v19 offset:16384
    v_accvgpr_read_b32 v15, a242
    v_mfma_f32_16x16x32_bf16 v[204:207], v[172:175], a[44:47], v[204:207]
    s_waitcnt vmcnt(33) lgkmcnt(7)
    ds_read_b64_tr_b16 v[166:167], v19 offset:18432
    v_accvgpr_read_b32 v16, a243
    v_mfma_f32_16x16x32_bf16 v[192:195], v[176:179], a[48:51], v[192:195]
    ds_read_b64_tr_b16 v[168:169], v18 offset:32768
    v_mfma_f32_16x16x32_bf16 v[200:203], v[176:179], a[52:55], v[200:203]
    ds_read_b64_tr_b16 v[170:171], v18 offset:34816
    buffer_load_dwordx4 a[172:175], v22, s[24:27], s32 offen offset:2048 sc1
    v_mfma_f32_16x16x32_bf16 v[196:199], v[180:183], a[48:51], v[196:199]
    ds_read_b64_tr_b16 v[172:173], v19 offset:32768
    v_mfma_f32_16x16x32_bf16 v[204:207], v[180:183], a[52:55], v[204:207]
    s_waitcnt vmcnt(31) lgkmcnt(7)
    ds_read_b64_tr_b16 v[174:175], v19 offset:34816
    v_mfma_f32_16x16x32_bf16 v[192:195], v[184:187], a[56:59], v[192:195]
    ds_read_b64_tr_b16 v[176:177], v18 offset:49152
    v_mfma_f32_16x16x32_bf16 v[200:203], v[184:187], a[60:63], v[200:203]
    ds_read_b64_tr_b16 v[178:179], v18 offset:51200
    buffer_load_dwordx4 a[176:179], v0, s[24:27], s33 offen offset:2048 sc1
    v_mfma_f32_16x16x32_bf16 v[196:199], v[188:191], a[56:59], v[196:199]
    ds_read_b64_tr_b16 v[180:181], v19 offset:49152
    v_mfma_f32_16x16x32_bf16 v[204:207], v[188:191], a[60:63], v[204:207]
    s_waitcnt vmcnt(30) lgkmcnt(7)
    ds_read_b64_tr_b16 v[182:183], v19 offset:51200
    v_mfma_f32_16x16x32_bf16 v[192:195], v[160:163], a[64:67], v[192:195]
    ds_read_b64_tr_b16 v[184:185], v6 offset:0
    v_xor_b32 v18, 0x2000, v18
    v_mfma_f32_16x16x32_bf16 v[200:203], v[160:163], a[68:71], v[200:203]
    ds_read_b64_tr_b16 v[186:187], v6 offset:2048
    buffer_load_dwordx4 a[180:183], v22, s[24:27], s33 offen offset:2048 sc1
    v_mfma_f32_16x16x32_bf16 v[196:199], v[164:167], a[64:67], v[196:199]
    ds_read_b64_tr_b16 v[188:189], v7 offset:0
    v_xor_b32 v19, 0x2000, v19
    v_mfma_f32_16x16x32_bf16 v[204:207], v[164:167], a[68:71], v[204:207]
    s_waitcnt vmcnt(29) lgkmcnt(7)
    ds_read_b64_tr_b16 v[190:191], v7 offset:2048
    v_mfma_f32_16x16x32_bf16 v[192:195], v[168:171], a[72:75], v[192:195]
    ds_read_b64_tr_b16 v[160:161], v6 offset:16384
    v_mfma_f32_16x16x32_bf16 v[200:203], v[168:171], a[76:79], v[200:203]
    ds_read_b64_tr_b16 v[162:163], v6 offset:18432
    buffer_load_dwordx4 a[184:187], v0, s[24:27], s34 offen offset:2048 sc1
    v_mfma_f32_16x16x32_bf16 v[196:199], v[172:175], a[72:75], v[196:199]
    ds_read_b64_tr_b16 v[164:165], v7 offset:16384
    v_mfma_f32_16x16x32_bf16 v[204:207], v[172:175], a[76:79], v[204:207]
    s_waitcnt vmcnt(28) lgkmcnt(7)
    ds_read_b64_tr_b16 v[166:167], v7 offset:18432
    v_mfma_f32_16x16x32_bf16 v[192:195], v[176:179], a[80:83], v[192:195]
    ds_read_b64_tr_b16 v[168:169], v6 offset:32768
    v_mfma_f32_16x16x32_bf16 v[200:203], v[176:179], a[84:87], v[200:203]
    ds_read_b64_tr_b16 v[170:171], v6 offset:34816
    buffer_load_dwordx4 a[188:191], v22, s[24:27], s34 offen offset:2048 sc1
    v_mfma_f32_16x16x32_bf16 v[196:199], v[180:183], a[80:83], v[196:199]
    ds_read_b64_tr_b16 v[172:173], v7 offset:32768
    v_mfma_f32_16x16x32_bf16 v[204:207], v[180:183], a[84:87], v[204:207]
    s_waitcnt vmcnt(27) lgkmcnt(7)
    ds_read_b64_tr_b16 v[174:175], v7 offset:34816
    v_mfma_f32_16x16x32_bf16 v[192:195], v[184:187], a[88:91], v[192:195]
    ds_read_b64_tr_b16 v[176:177], v20 offset:0
    v_mfma_f32_16x16x32_bf16 v[200:203], v[184:187], a[92:95], v[200:203]
    ds_read_b64_tr_b16 v[178:179], v20 offset:2048
    buffer_load_dwordx4 a[192:195], v0, s[24:27], s35 offen offset:2048 sc1
    v_mfma_f32_16x16x32_bf16 v[196:199], v[188:191], a[88:91], v[196:199]
    ds_read_b64_tr_b16 v[180:181], v21 offset:0
    v_mfma_f32_16x16x32_bf16 v[204:207], v[188:191], a[92:95], v[204:207]
    s_waitcnt vmcnt(26) lgkmcnt(7)
    ds_read_b64_tr_b16 v[182:183], v21 offset:2048
    v_mfma_f32_16x16x32_bf16 v[192:195], v[160:163], a[96:99], v[192:195]
    ds_read_b64_tr_b16 v[184:185], v18 offset:4096
    v_xor_b32 v6, 0x2000, v6
    v_mfma_f32_16x16x32_bf16 v[200:203], v[160:163], a[100:103], v[200:203]
    ds_read_b64_tr_b16 v[186:187], v18 offset:6144
    buffer_load_dwordx4 a[196:199], v22, s[24:27], s35 offen offset:2048 sc1
    v_mfma_f32_16x16x32_bf16 v[196:199], v[164:167], a[96:99], v[196:199]
    ds_read_b64_tr_b16 v[188:189], v19 offset:4096
    v_xor_b32 v7, 0x2000, v7
    v_mfma_f32_16x16x32_bf16 v[204:207], v[164:167], a[100:103], v[204:207]
    s_waitcnt vmcnt(25) lgkmcnt(7)
    ds_read_b64_tr_b16 v[190:191], v19 offset:6144
    v_mfma_f32_16x16x32_bf16 v[192:195], v[168:171], a[104:107], v[192:195]
    ds_read_b64_tr_b16 v[160:161], v18 offset:20480
    v_mfma_f32_16x16x32_bf16 v[200:203], v[168:171], a[108:111], v[200:203]
    ds_read_b64_tr_b16 v[162:163], v18 offset:22528
    buffer_load_dwordx4 a[200:203], v0, s[24:27], s36 offen offset:2048 sc1
    v_mfma_f32_16x16x32_bf16 v[196:199], v[172:175], a[104:107], v[196:199]
    ds_read_b64_tr_b16 v[164:165], v19 offset:20480
    v_mfma_f32_16x16x32_bf16 v[204:207], v[172:175], a[108:111], v[204:207]
    s_waitcnt lgkmcnt(7)
    ds_read_b64_tr_b16 v[166:167], v19 offset:22528
    v_mfma_f32_16x16x32_bf16 v[208:211], v[176:179], a[0:3], v[88:91]
    ds_read_b64_tr_b16 v[168:169], v18 offset:36864
    v_mfma_f32_16x16x32_bf16 v[216:219], v[176:179], a[4:7], v[88:91]
    ds_read_b64_tr_b16 v[170:171], v18 offset:38912
    buffer_load_dwordx4 a[204:207], v22, s[24:27], s36 offen offset:2048 sc1
    v_mfma_f32_16x16x32_bf16 v[212:215], v[180:183], a[0:3], v[92:95]
    ds_read_b64_tr_b16 v[172:173], v19 offset:36864
    v_mfma_f32_16x16x32_bf16 v[220:223], v[180:183], a[4:7], v[92:95]
    s_waitcnt lgkmcnt(7)
    ds_read_b64_tr_b16 v[174:175], v19 offset:38912
    v_mfma_f32_16x16x32_bf16 v[192:195], v[184:187], a[112:115], v[192:195]
    ds_read_b64_tr_b16 v[176:177], v18 offset:53248
    v_mfma_f32_16x16x32_bf16 v[200:203], v[184:187], a[116:119], v[200:203]
    ds_read_b64_tr_b16 v[178:179], v18 offset:55296
    buffer_load_dwordx4 a[208:211], v0, s[24:27], s37 offen offset:2048 sc1
    v_mfma_f32_16x16x32_bf16 v[196:199], v[188:191], a[112:115], v[196:199]
    ds_read_b64_tr_b16 v[180:181], v19 offset:53248
    v_mfma_f32_16x16x32_bf16 v[204:207], v[188:191], a[116:119], v[204:207]
    s_waitcnt vmcnt(25) lgkmcnt(7)
    ds_read_b64_tr_b16 v[182:183], v19 offset:55296
    v_mfma_f32_16x16x32_bf16 v[192:195], v[160:163], a[120:123], v[192:195]
    ds_read_b64_tr_b16 v[184:185], v6 offset:4096
    v_xor_b32 v18, 0x2000, v18
    v_mfma_f32_16x16x32_bf16 v[200:203], v[160:163], a[124:127], v[200:203]
    ds_read_b64_tr_b16 v[186:187], v6 offset:6144
    buffer_load_dwordx4 a[212:215], v22, s[24:27], s37 offen offset:2048 sc1
    v_mfma_f32_16x16x32_bf16 v[196:199], v[164:167], a[120:123], v[196:199]
    ds_read_b64_tr_b16 v[188:189], v7 offset:4096
    v_xor_b32 v19, 0x2000, v19
    v_mfma_f32_16x16x32_bf16 v[204:207], v[164:167], a[124:127], v[204:207]
    s_waitcnt vmcnt(24) lgkmcnt(7)
    ds_read_b64_tr_b16 v[190:191], v7 offset:6144
    v_mfma_f32_16x16x32_bf16 v[192:195], v[168:171], a[128:131], v[192:195]
    ds_read_b64_tr_b16 v[160:161], v6 offset:20480
    v_mfma_f32_16x16x32_bf16 v[200:203], v[168:171], a[132:135], v[200:203]
    ds_read_b64_tr_b16 v[162:163], v6 offset:22528
    buffer_load_dwordx4 a[216:219], v0, s[24:27], s38 offen offset:2048 sc1
    v_mfma_f32_16x16x32_bf16 v[196:199], v[172:175], a[128:131], v[196:199]
    ds_read_b64_tr_b16 v[164:165], v7 offset:20480
    v_mfma_f32_16x16x32_bf16 v[204:207], v[172:175], a[132:135], v[204:207]
    s_waitcnt vmcnt(23) lgkmcnt(7)
    ds_read_b64_tr_b16 v[166:167], v7 offset:22528
    v_mfma_f32_16x16x32_bf16 v[192:195], v[176:179], a[136:139], v[192:195]
    ds_read_b64_tr_b16 v[168:169], v6 offset:36864
    v_accvgpr_read_b32 v25, a236
    v_mfma_f32_16x16x32_bf16 v[200:203], v[176:179], a[140:143], v[200:203]
    ds_read_b64_tr_b16 v[170:171], v6 offset:38912
    buffer_load_dwordx4 a[220:223], v22, s[24:27], s38 offen offset:2048 sc1
    v_mfma_f32_16x16x32_bf16 v[196:199], v[180:183], a[136:139], v[196:199]
    ds_read_b64_tr_b16 v[172:173], v7 offset:36864
    v_accvgpr_read_b32 v26, a239
L_stub3:
    s_cbranch_execz L_tour_back
    s_nop 0
    v_mfma_f32_16x16x32_bf16 v[204:207], v[180:183], a[140:143], v[204:207]
    s_waitcnt vmcnt(22) lgkmcnt(7)
    ds_read_b64_tr_b16 v[174:175], v7 offset:38912
    v_mov_b32 v28, v31
    v_mfma_f32_16x16x32_bf16 v[192:195], v[184:187], a[144:147], v[192:195]
    ds_read_b64_tr_b16 v[176:177], v18 offset:4096
    v_xor_b32 v6, 0x2000, v6
    v_mfma_f32_16x16x32_bf16 v[200:203], v[184:187], a[148:151], v[200:203]
    ds_read_b64_tr_b16 v[178:179], v18 offset:6144
    v_xor_b32 v7, 0x2000, v7
    v_mfma_f32_16x16x32_bf16 v[196:199], v[188:191], a[144:147], v[196:199]
    ds_read_b64_tr_b16 v[180:181], v19 offset:4096
    s_mov_b32 exec_hi, 1
    v_mov_b32 v28, 0
    s_mov_b32 exec_hi, -1
    v_mfma_f32_16x16x32_bf16 v[204:207], v[188:191], a[148:151], v[204:207]
    s_waitcnt vmcnt(18) lgkmcnt(7)
    ds_read_b64_tr_b16 v[182:183], v19 offset:6144
    s_mov_b64 s[64:65], 0
    v_mfma_f32_16x16x32_bf16 v[192:195], v[160:163], a[152:155], v[192:195]
    s_mov_b32 s30, 0
    ds_read_b64_tr_b16 v[184:185], v18 offset:20480
    s_lshl_b32 s62, s4, 11
    v_mfma_f32_16x16x32_bf16 v[200:203], v[160:163], a[156:159], v[200:203]
    s_add_u32 m0, s62, 131072
    ds_read_b64_tr_b16 v[186:187], v18 offset:22528
    v_mfma_f32_16x16x32_bf16 v[196:199], v[164:167], a[152:155], v[196:199]
    ds_read_b64_tr_b16 v[188:189], v19 offset:20480
    v_mfma_f32_16x16x32_bf16 v[204:207], v[164:167], a[156:159], v[204:207]
    s_waitcnt vmcnt(14) lgkmcnt(7)
    ds_read_b64_tr_b16 v[190:191], v19 offset:22528
    s_mov_b64 exec, 0xff
    buffer_atomic_swap v31, v12, s[24:27], s52 offen offset:0 sc1
    s_mov_b64 exec, -1
    v_mfma_f32_16x16x32_bf16 v[192:195], v[168:171], a[160:163], v[192:195]
    ds_read_b64_tr_b16 v[160:161], v18 offset:36864
    v_mfma_f32_16x16x32_bf16 v[200:203], v[168:171], a[164:167], v[200:203]
    ds_read_b64_tr_b16 v[162:163], v18 offset:38912
    v_mfma_f32_16x16x32_bf16 v[196:199], v[172:175], a[160:163], v[196:199]
    ds_read_b64_tr_b16 v[164:165], v19 offset:36864
    v_mfma_f32_16x16x32_bf16 v[204:207], v[172:175], a[164:167], v[204:207]
    s_waitcnt vmcnt(13) lgkmcnt(7)
    ds_read_b64_tr_b16 v[166:167], v19 offset:38912
    v_mfma_f32_16x16x32_bf16 v[192:195], v[176:179], a[168:171], v[192:195]
    ds_read_b64_tr_b16 v[168:169], v18 offset:53248
    v_mfma_f32_16x16x32_bf16 v[200:203], v[176:179], a[172:175], v[200:203]
    ds_read_b64_tr_b16 v[170:171], v18 offset:55296
    v_mfma_f32_16x16x32_bf16 v[196:199], v[180:183], a[168:171], v[196:199]
    ds_read_b64_tr_b16 v[172:173], v19 offset:53248
    v_mfma_f32_16x16x32_bf16 v[204:207], v[180:183], a[172:175], v[204:207]
    s_waitcnt vmcnt(11) lgkmcnt(7)
    ds_read_b64_tr_b16 v[174:175], v19 offset:55296
    v_mfma_f32_16x16x32_bf16 v[192:195], v[184:187], a[176:179], v[192:195]
    ds_read_b64_tr_b16 v[176:177], v6 offset:4096
    v_mfma_f32_16x16x32_bf16 v[200:203], v[184:187], a[180:183], v[200:203]
    ds_read_b64_tr_b16 v[178:179], v6 offset:6144
    v_mfma_f32_16x16x32_bf16 v[196:199], v[188:191], a[176:179], v[196:199]
    ds_read_b64_tr_b16 v[180:181], v7 offset:4096
    v_mfma_f32_16x16x32_bf16 v[204:207], v[188:191], a[180:183], v[204:207]
    s_waitcnt vmcnt(9) lgkmcnt(7)
    ds_read_b64_tr_b16 v[182:183], v7 offset:6144
    v_mfma_f32_16x16x32_bf16 v[192:195], v[160:163], a[184:187], v[192:195]
    ds_read_b64_tr_b16 v[184:185], v6 offset:20480
    v_mfma_f32_16x16x32_bf16 v[200:203], v[160:163], a[188:191], v[200:203]
    ds_read_b64_tr_b16 v[186:187], v6 offset:22528
    v_mfma_f32_16x16x32_bf16 v[196:199], v[164:167], a[184:187], v[196:199]
    ds_read_b64_tr_b16 v[188:189], v7 offset:20480
    v_mfma_f32_16x16x32_bf16 v[204:207], v[164:167], a[188:191], v[204:207]
    s_waitcnt vmcnt(7) lgkmcnt(7)
    ds_read_b64_tr_b16 v[190:191], v7 offset:22528
    v_mfma_f32_16x16x32_bf16 v[192:195], v[168:171], a[192:195], v[192:195]
    ds_read_b64_tr_b16 v[160:161], v6 offset:36864
    v_mfma_f32_16x16x32_bf16 v[200:203], v[168:171], a[196:199], v[200:203]
    ds_read_b64_tr_b16 v[162:163], v6 offset:38912
    v_mfma_f32_16x16x32_bf16 v[196:199], v[172:175], a[192:195], v[196:199]
    ds_read_b64_tr_b16 v[164:165], v7 offset:36864
    v_mfma_f32_16x16x32_bf16 v[204:207], v[172:175], a[196:199], v[204:207]
    s_waitcnt vmcnt(5) lgkmcnt(7)
    ds_read_b64_tr_b16 v[166:167], v7 offset:38912
    v_mfma_f32_16x16x32_bf16 v[192:195], v[176:179], a[200:203], v[192:195]
    ds_read_b64_tr_b16 v[168:169], v20 offset:16384
    v_mfma_f32_16x16x32_bf16 v[200:203], v[176:179], a[204:207], v[200:203]
    ds_read_b64_tr_b16 v[170:171], v20 offset:18432
    v_mfma_f32_16x16x32_bf16 v[196:199], v[180:183], a[200:203], v[196:199]
    ds_read_b64_tr_b16 v[172:173], v21 offset:16384
    v_mfma_f32_16x16x32_bf16 v[204:207], v[180:183], a[204:207], v[204:207]
    s_waitcnt vmcnt(3) lgkmcnt(7)
    ds_read_b64_tr_b16 v[174:175], v21 offset:18432
    s_mov_b64 exec, 0x1
    buffer_atomic_swap v31, v26, s[24:27], s30 offen offset:0 sc1
    s_mov_b64 exec, -1
    v_mfma_f32_16x16x32_bf16 v[192:195], v[184:187], a[208:211], v[192:195]
    ds_read_b64_tr_b16 v[176:177], v20 offset:32768
    v_mfma_f32_16x16x32_bf16 v[200:203], v[184:187], a[212:215], v[200:203]
    ds_read_b64_tr_b16 v[178:179], v20 offset:34816
    v_mfma_f32_16x16x32_bf16 v[196:199], v[188:191], a[208:211], v[196:199]
    ds_read_b64_tr_b16 v[180:181], v21 offset:32768
    v_mfma_f32_16x16x32_bf16 v[204:207], v[188:191], a[212:215], v[204:207]
    s_waitcnt vmcnt(2) lgkmcnt(7)
    ds_read_b64_tr_b16 v[182:183], v21 offset:34816
    v_mfma_f32_16x16x32_bf16 v[192:195], v[160:163], a[216:219], v[192:195]
    ds_read_b64_tr_b16 v[184:185], v20 offset:49152
    v_mfma_f32_16x16x32_bf16 v[200:203], v[160:163], a[220:223], v[200:203]
    ds_read_b64_tr_b16 v[186:187], v20 offset:51200
    v_mfma_f32_16x16x32_bf16 v[196:199], v[164:167], a[216:219], v[196:199]
    ds_read_b64_tr_b16 v[188:189], v21 offset:49152
    v_mfma_f32_16x16x32_bf16 v[204:207], v[164:167], a[220:223], v[204:207]
    s_waitcnt lgkmcnt(7)
    ds_read_b64_tr_b16 v[190:191], v21 offset:51200
    s_mov_b32 exec_hi, 1
    global_atomic_or v28, v25, v30, s[24:25] sc0 sc1
    s_mov_b64 exec, -1
    v_mfma_f32_16x16x32_bf16 v[208:211], v[168:171], a[8:11], v[208:211]
    ds_read_b64_tr_b16 v[160:161], v8 offset:0
    v_xor_b32 v20, 0x2000, v20
    v_xor_b32 v21, 0x2000, v21
    v_mfma_f32_16x16x32_bf16 v[216:219], v[168:171], a[12:15], v[216:219]
    ds_read_b64_tr_b16 v[162:163], v8 offset:2048
    v_mfma_f32_16x16x32_bf16 v[212:215], v[172:175], a[8:11], v[212:215]
    ds_read_b64_tr_b16 v[164:165], v9 offset:0
    v_cvt_pk_bf16_f32 v96, v192, v193
    v_cvt_pk_bf16_f32 v97, v194, v195
    v_cvt_pk_bf16_f32 v98, v196, v197
    v_mfma_f32_16x16x32_bf16 v[220:223], v[172:175], a[12:15], v[220:223]
    s_waitcnt lgkmcnt(7)
    ds_read_b64_tr_b16 v[166:167], v9 offset:2048
    v_cvt_pk_bf16_f32 v99, v198, v199
    buffer_store_dwordx4 v[96:99], v29, s[24:27], s13 offen offset:0 sc1
    v_cvt_pk_bf16_f32 v100, v200, v201
    s_lshl_b64 exec, 1, 32
    global_atomic_or v28, v25, v30, s[24:25] sc0 sc1
    s_mov_b64 exec, -1
    v_mfma_f32_16x16x32_bf16 v[208:211], v[176:179], a[16:19], v[208:211]
    ds_read_b64_tr_b16 v[168:169], v8 offset:16384
    v_cvt_pk_bf16_f32 v101, v202, v203
    v_cvt_pk_bf16_f32 v102, v204, v205
    v_cvt_pk_bf16_f32 v103, v206, v207
    v_mfma_f32_16x16x32_bf16 v[216:219], v[176:179], a[20:23], v[216:219]
    ds_read_b64_tr_b16 v[170:171], v8 offset:18432
    buffer_store_dwordx4 v[100:103], v29, s[24:27], s13 offen offset:1024 sc1
    v_add3_u32 v192, v96, v97, v98
    v_add3_u32 v193, v100, v101, v102
    v_mfma_f32_16x16x32_bf16 v[212:215], v[180:183], a[16:19], v[212:215]
    ds_read_b64_tr_b16 v[172:173], v9 offset:16384
    v_xad_u32 v192, v99, v31, v192
    v_xad_u32 v193, v103, v31, v193
    v_lshl_add_u32 v192, v193, 1, v192
    v_mfma_f32_16x16x32_bf16 v[220:223], v[180:183], a[20:23], v[220:223]
    s_waitcnt lgkmcnt(7)
    ds_read_b64_tr_b16 v[174:175], v9 offset:18432
    buffer_store_dword v192, v2, s[24:27], s13 offen offset:2048 sc1
    v_mfma_f32_16x16x32_bf16 v[208:211], v[184:187], a[24:27], v[208:211]
    ds_read_b64_tr_b16 v[176:177], v8 offset:32768
    v_mfma_f32_16x16x32_bf16 v[216:219], v[184:187], a[28:31], v[216:219]
    ds_read_b64_tr_b16 v[178:179], v8 offset:34816
    v_mfma_f32_16x16x32_bf16 v[212:215], v[188:191], a[24:27], v[212:215]
    ds_read_b64_tr_b16 v[180:181], v9 offset:32768
    v_mfma_f32_16x16x32_bf16 v[220:223], v[188:191], a[28:31], v[220:223]
    s_waitcnt lgkmcnt(7)
    ds_read_b64_tr_b16 v[182:183], v9 offset:34816
    v_mfma_f32_16x16x32_bf16 v[208:211], v[160:163], a[32:35], v[208:211]
    ds_read_b64_tr_b16 v[184:185], v20 offset:0
    v_xor_b32 v8, 0x2000, v8
    v_mfma_f32_16x16x32_bf16 v[216:219], v[160:163], a[36:39], v[216:219]
    ds_read_b64_tr_b16 v[186:187], v20 offset:2048
    v_xor_b32 v9, 0x2000, v9
    v_mfma_f32_16x16x32_bf16 v[212:215], v[164:167], a[32:35], v[212:215]
    ds_read_b64_tr_b16 v[188:189], v21 offset:0
    v_mfma_f32_16x16x32_bf16 v[220:223], v[164:167], a[36:39], v[220:223]
    s_waitcnt lgkmcnt(7)
    ds_read_b64_tr_b16 v[190:191], v21 offset:2048
    v_mfma_f32_16x16x32_bf16 v[208:211], v[168:171], a[40:43], v[208:211]
    ds_read_b64_tr_b16 v[160:161], v20 offset:16384
    v_mfma_f32_16x16x32_bf16 v[216:219], v[168:171], a[44:47], v[216:219]
    ds_read_b64_tr_b16 v[162:163], v20 offset:18432
    v_mfma_f32_16x16x32_bf16 v[212:215], v[172:175], a[40:43], v[212:215]
    ds_read_b64_tr_b16 v[164:165], v21 offset:16384
    v_mfma_f32_16x16x32_bf16 v[220:223], v[172:175], a[44:47], v[220:223]
    s_waitcnt lgkmcnt(7)
    ds_read_b64_tr_b16 v[166:167], v21 offset:18432
    s_mov_b32 exec_hi, 1
    global_atomic_or v28, v25, v30, s[24:25] sc0 sc1
    s_mov_b64 exec, -1
    v_mfma_f32_16x16x32_bf16 v[208:211], v[176:179], a[48:51], v[208:211]
    ds_read_b64_tr_b16 v[168:169], v20 offset:32768
    v_mfma_f32_16x16x32_bf16 v[216:219], v[176:179], a[52:55], v[216:219]
    ds_read_b64_tr_b16 v[170:171], v20 offset:34816
    v_mfma_f32_16x16x32_bf16 v[212:215], v[180:183], a[48:51], v[212:215]
    ds_read_b64_tr_b16 v[172:173], v21 offset:32768
    v_mfma_f32_16x16x32_bf16 v[220:223], v[180:183], a[52:55], v[220:223]
    s_waitcnt lgkmcnt(7)
    ds_read_b64_tr_b16 v[174:175], v21 offset:34816
    v_mfma_f32_16x16x32_bf16 v[208:211], v[184:187], a[56:59], v[208:211]
    ds_read_b64_tr_b16 v[176:177], v20 offset:49152
    v_mfma_f32_16x16x32_bf16 v[216:219], v[184:187], a[60:63], v[216:219]
    ds_read_b64_tr_b16 v[178:179], v20 offset:51200
    v_mfma_f32_16x16x32_bf16 v[212:215], v[188:191], a[56:59], v[212:215]
    ds_read_b64_tr_b16 v[180:181], v21 offset:49152
    v_mfma_f32_16x16x32_bf16 v[220:223], v[188:191], a[60:63], v[220:223]
    s_waitcnt lgkmcnt(7)
    ds_read_b64_tr_b16 v[182:183], v21 offset:51200
    v_mfma_f32_16x16x32_bf16 v[208:211], v[160:163], a[64:67], v[208:211]
    ds_read_b64_tr_b16 v[184:185], v8 offset:0
    v_xor_b32 v20, 0x2000, v20
    v_mfma_f32_16x16x32_bf16 v[216:219], v[160:163], a[68:71], v[216:219]
    ds_read_b64_tr_b16 v[186:187], v8 offset:2048
    v_xor_b32 v21, 0x2000, v21
    v_mfma_f32_16x16x32_bf16 v[212:215], v[164:167], a[64:67], v[212:215]
    ds_read_b64_tr_b16 v[188:189], v9 offset:0
    v_mfma_f32_16x16x32_bf16 v[220:223], v[164:167], a[68:71], v[220:223]
    s_waitcnt lgkmcnt(7)
    ds_read_b64_tr_b16 v[190:191], v9 offset:2048
    v_mfma_f32_16x16x32_bf16 v[208:211], v[168:171], a[72:75], v[208:211]
    ds_read_b64_tr_b16 v[160:161], v8 offset:16384
    v_mfma_f32_16x16x32_bf16 v[216:219], v[168:171], a[76:79], v[216:219]
    ds_read_b64_tr_b16 v[162:163], v8 offset:18432
    v_mfma_f32_16x16x32_bf16 v[212:215], v[172:175], a[72:75], v[212:215]
    ds_read_b64_tr_b16 v[164:165], v9 offset:16384
    v_mfma_f32_16x16x32_bf16 v[220:223], v[172:175], a[76:79], v[220:223]
    s_waitcnt lgkmcnt(7)
    ds_read_b64_tr_b16 v[166:167], v9 offset:18432
    v_mfma_f32_16x16x32_bf16 v[208:211], v[176:179], a[80:83], v[208:211]
    ds_read_b64_tr_b16 v[168:169], v8 offset:32768
    v_mfma_f32_16x16x32_bf16 v[216:219], v[176:179], a[84:87], v[216:219]
    ds_read_b64_tr_b16 v[170:171], v8 offset:34816
    v_mfma_f32_16x16x32_bf16 v[212:215], v[180:183], a[80:83], v[212:215]
    ds_read_b64_tr_b16 v[172:173], v9 offset:32768
    v_mfma_f32_16x16x32_bf16 v[220:223], v[180:183], a[84:87], v[220:223]
    s_waitcnt lgkmcnt(7)
    ds_read_b64_tr_b16 v[174:175], v9 offset:34816
    v_mfma_f32_16x16x32_bf16 v[208:211], v[184:187], a[88:91], v[208:211]
    v_cmp_ne_u32 vcc, s3, v28
    ds_read_b64_tr_b16 v[176:177], v20 offset:4096
    v_mfma_f32_16x16x32_bf16 v[216:219], v[184:187], a[92:95], v[216:219]
    s_or_b32 s62, vcc_lo, s64
    s_cbranch_scc0 L_cold_47
L_back_48:
    ds_read_b64_tr_b16 v[178:179], v20 offset:6144
    v_mfma_f32_16x16x32_bf16 v[212:215], v[188:191], a[88:91], v[212:215]
    ds_read_b64_tr_b16 v[180:181], v21 offset:4096
    v_xor_b32 v8, 0x2000, v8
    v_mfma_f32_16x16x32_bf16 v[220:223], v[188:191], a[92:95], v[220:223]
    s_waitcnt lgkmcnt(7)
    ds_read_b64_tr_b16 v[182:183], v21 offset:6144
    v_xor_b32 v9, 0x2000, v9
    v_mfma_f32_16x16x32_bf16 v[208:211], v[160:163], a[96:99], v[208:211]
    ds_read_b64_tr_b16 v[184:185], v20 offset:20480
    v_mfma_f32_16x16x32_bf16 v[216:219], v[160:163], a[100:103], v[216:219]
    ds_read_b64_tr_b16 v[186:187], v20 offset:22528
    v_mfma_f32_16x16x32_bf16 v[212:215], v[164:167], a[96:99], v[212:215]
    ds_read_b64_tr_b16 v[188:189], v21 offset:20480
    v_mfma_f32_16x16x32_bf16 v[220:223], v[164:167], a[100:103], v[220:223]
    s_waitcnt lgkmcnt(7)
    ds_read_b64_tr_b16 v[190:191], v21 offset:22528
    v_mfma_f32_16x16x32_bf16 v[208:211], v[168:171], a[104:107], v[208:211]
    ds_read_b64_tr_b16 v[160:161], v20 offset:36864
    v_mfma_f32_16x16x32_bf16 v[216:219], v[168:171], a[108:111], v[216:219]
    v_cmp_ne_u32 vcc, s3, v28
    ds_read_b64_tr_b16 v[162:163], v20 offset:38912
    v_mfma_f32_16x16x32_bf16 v[212:215], v[172:175], a[104:107], v[212:215]
    s_or_b32 s62, vcc_hi, s65
    s_cbranch_scc0 L_cold_49
L_back_50:
    ds_read_b64_tr_b16 v[164:165], v21 offset:36864
    v_mfma_f32_16x16x32_bf16 v[220:223], v[172:175], a[108:111], v[220:223]
    s_waitcnt lgkmcnt(7)
    ds_read_b64_tr_b16 v[166:167], v21 offset:38912
    v_mfma_f32_16x16x32_bf16 v[208:211], v[176:179], a[112:115], v[208:211]
    ds_read_b64_tr_b16 v[168:169], v20 offset:53248
    v_mfma_f32_16x16x32_bf16 v[216:219], v[176:179], a[116:119], v[216:219]
    ds_read_b64_tr_b16 v[170:171], v20 offset:55296
    v_mfma_f32_16x16x32_bf16 v[212:215], v[180:183], a[112:115], v[212:215]
    ds_read_b64_tr_b16 v[172:173], v21 offset:53248
    v_mfma_f32_16x16x32_bf16 v[220:223], v[180:183], a[116:119], v[220:223]
    s_waitcnt lgkmcnt(7)
    ds_read_b64_tr_b16 v[174:175], v21 offset:55296
    v_mfma_f32_16x16x32_bf16 v[208:211], v[184:187], a[120:123], v[208:211]
    v_cmp_ne_u32 vcc, s3, v28
    ds_read_b64_tr_b16 v[176:177], v8 offset:4096
    v_mfma_f32_16x16x32_bf16 v[216:219], v[184:187], a[124:127], v[216:219]
    s_or_b32 s62, vcc_lo, s64
    s_cbranch_scc0 L_cold_51
L_back_52:
    ds_read_b64_tr_b16 v[178:179], v8 offset:6144
    v_mfma_f32_16x16x32_bf16 v[212:215], v[188:191], a[120:123], v[212:215]
    ds_read_b64_tr_b16 v[180:181], v9 offset:4096
    v_xor_b32 v20, 0x2000, v20
    v_mfma_f32_16x16x32_bf16 v[220:223], v[188:191], a[124:127], v[220:223]
    s_waitcnt lgkmcnt(7)
    ds_read_b64_tr_b16 v[182:183], v9 offset:6144
    v_xor_b32 v21, 0x2000, v21
    s_cmp_eq_u32 s64, 0
    s_cbranch_scc1 L_cold_53
L_back_54:
    v_mfma_f32_16x16x32_bf16 v[208:211], v[160:163], a[128:131], v[208:211]
    ds_read_b64_tr_b16 v[184:185], v8 offset:20480
    v_mfma_f32_16x16x32_bf16 v[216:219], v[160:163], a[132:135], v[216:219]
    v_cmp_ne_u32 vcc, s3, v28
    ds_read_b64_tr_b16 v[186:187], v8 offset:22528
    v_mfma_f32_16x16x32_bf16 v[212:215], v[164:167], a[128:131], v[212:215]
    s_or_b32 s62, vcc_hi, s65
    s_cbranch_scc0 L_cold_55
L_back_56:
    ds_read_b64_tr_b16 v[188:189], v9 offset:20480
    v_mfma_f32_16x16x32_bf16 v[220:223], v[164:167], a[132:135], v[220:223]
    s_waitcnt lgkmcnt(7)
    ds_read_b64_tr_b16 v[190:191], v9 offset:22528
    s_cmp_eq_u32 s65, 0
    s_cbranch_scc1 L_cold_57
L_back_58:
    v_mfma_f32_16x16x32_bf16 v[208:211], v[168:171], a[136:139], v[208:211]
    ds_read_b64_tr_b16 v[160:161], v8 offset:36864
    v_mfma_f32_16x16x32_bf16 v[216:219], v[168:171], a[140:143], v[216:219]
    ds_read_b64_tr_b16 v[162:163], v8 offset:38912
    v_mfma_f32_16x16x32_bf16 v[212:215], v[172:175], a[136:139], v[212:215]
    ds_read_b64_tr_b16 v[164:165], v9 offset:36864
    v_mfma_f32_16x16x32_bf16 v[220:223], v[172:175], a[140:143], v[220:223]
    s_waitcnt lgkmcnt(7)
    ds_read_b64_tr_b16 v[166:167], v9 offset:38912
    v_mfma_f32_16x16x32_bf16 v[208:211], v[176:179], a[144:147], v[208:211]
    ds_read_b64_tr_b16 v[168:169], v20 offset:4096
    v_xor_b32 v8, 0x2000, v8
    v_mfma_f32_16x16x32_bf16 v[216:219], v[176:179], a[148:151], v[216:219]
    ds_read_b64_tr_b16 v[170:171], v20 offset:6144
    v_xor_b32 v9, 0x2000, v9
    v_mfma_f32_16x16x32_bf16 v[212:215], v[180:183], a[144:147], v[212:215]
    ds_read_b64_tr_b16 v[172:173], v21 offset:4096
    v_mfma_f32_16x16x32_bf16 v[220:223], v[180:183], a[148:151], v[220:223]
    s_waitcnt lgkmcnt(7)
    ds_read_b64_tr_b16 v[174:175], v21 offset:6144
    v_mfma_f32_16x16x32_bf16 v[208:211], v[184:187], a[152:155], v[208:211]
    ds_read_b64_tr_b16 v[176:177], v20 offset:20480
    v_mfma_f32_16x16x32_bf16 v[216:219], v[184:187], a[156:159], v[216:219]
    ds_read_b64_tr_b16 v[178:179], v20 offset:22528
    v_mfma_f32_16x16x32_bf16 v[212:215], v[188:191], a[152:155], v[212:215]
    ds_read_b64_tr_b16 v[180:181], v21 offset:20480
    v_mfma_f32_16x16x32_bf16 v[220:223], v[188:191], a[156:159], v[220:223]
    s_waitcnt lgkmcnt(7)
    ds_read_b64_tr_b16 v[182:183], v21 offset:22528
    v_mfma_f32_16x16x32_bf16 v[208:211], v[160:163], a[160:163], v[208:211]
    ds_read_b64_tr_b16 v[184:185], v20 offset:36864
    v_mfma_f32_16x16x32_bf16 v[216:219], v[160:163], a[164:167], v[216:219]
    ds_read_b64_tr_b16 v[186:187], v20 offset:38912
    v_mfma_f32_16x16x32_bf16 v[212:215], v[164:167], a[160:163], v[212:215]
    ds_read_b64_tr_b16 v[188:189], v21 offset:36864
    v_mfma_f32_16x16x32_bf16 v[220:223], v[164:167], a[164:167], v[220:223]
    s_waitcnt lgkmcnt(7)
    ds_read_b64_tr_b16 v[190:191], v21 offset:38912
    s_cmp_eq_u32 s65, 0
    s_cbranch_scc1 L_cold_59
L_back_60:
    v_mfma_f32_16x16x32_bf16 v[208:211], v[168:171], a[168:171], v[208:211]
    v_cmp_ne_u32 vcc, s3, v28
    ds_read_b64_tr_b16 v[160:161], v20 offset:53248
    v_mfma_f32_16x16x32_bf16 v[216:219], v[168:171], a[172:175], v[216:219]
    s_or_b32 s62, vcc_lo, s64
    s_cbranch_scc0 L_cold_61
L_back_62:
    ds_read_b64_tr_b16 v[162:163], v20 offset:55296
    v_mfma_f32_16x16x32_bf16 v[212:215], v[172:175], a[168:171], v[212:215]
    ds_read_b64_tr_b16 v[164:165], v21 offset:53248
    v_mfma_f32_16x16x32_bf16 v[220:223], v[172:175], a[172:175], v[220:223]
    s_waitcnt lgkmcnt(7)
    ds_read_b64_tr_b16 v[166:167], v21 offset:55296
    v_mfma_f32_16x16x32_bf16 v[208:211], v[176:179], a[176:179], v[208:211]
    ds_read_b64_tr_b16 v[168:169], v8 offset:4096
    v_mfma_f32_16x16x32_bf16 v[216:219], v[176:179], a[180:183], v[216:219]
    ds_read_b64_tr_b16 v[170:171], v8 offset:6144
    v_mfma_f32_16x16x32_bf16 v[212:215], v[180:183], a[176:179], v[212:215]
    ds_read_b64_tr_b16 v[172:173], v9 offset:4096
    v_mfma_f32_16x16x32_bf16 v[220:223], v[180:183], a[180:183], v[220:223]
    s_waitcnt lgkmcnt(7)
    ds_read_b64_tr_b16 v[174:175], v9 offset:6144
    v_mfma_f32_16x16x32_bf16 v[208:211], v[184:187], a[184:187], v[208:211]
    ds_read_b64_tr_b16 v[176:177], v8 offset:20480
    v_mfma_f32_16x16x32_bf16 v[216:219], v[184:187], a[188:191], v[216:219]
    ds_read_b64_tr_b16 v[178:179], v8 offset:22528
    v_mfma_f32_16x16x32_bf16 v[212:215], v[188:191], a[184:187], v[212:215]
    ds_read_b64_tr_b16 v[180:181], v9 offset:20480
    v_mfma_f32_16x16x32_bf16 v[220:223], v[188:191], a[188:191], v[220:223]
    s_waitcnt lgkmcnt(7)
    ds_read_b64_tr_b16 v[182:183], v9 offset:22528
    v_mfma_f32_16x16x32_bf16 v[208:211], v[160:163], a[192:195], v[208:211]
    ds_read_b64_tr_b16 v[184:185], v8 offset:36864
    v_mfma_f32_16x16x32_bf16 v[216:219], v[160:163], a[196:199], v[216:219]
    ds_read_b64_tr_b16 v[186:187], v8 offset:38912
    v_mfma_f32_16x16x32_bf16 v[212:215], v[164:167], a[192:195], v[212:215]
    ds_read_b64_tr_b16 v[188:189], v9 offset:36864
    v_mfma_f32_16x16x32_bf16 v[220:223], v[164:167], a[196:199], v[220:223]
    s_waitcnt lgkmcnt(7)
    ds_read_b64_tr_b16 v[190:191], v9 offset:38912
    s_and_b32 s62, s64, s65
    s_cbranch_scc0 L_cold_63
L_back_64:
    s_waitcnt vmcnt(0)
    v_mfma_f32_16x16x32_bf16 v[208:211], v[168:171], a[200:203], v[208:211]
    ds_read_b64_tr_b16 v[104:105], v13 offset:0
    v_add3_u32 v64, v32, v33, v34
    v_mfma_f32_16x16x32_bf16 v[216:219], v[168:171], a[204:207], v[216:219]
    ds_read_b64_tr_b16 v[106:107], v13 offset:1024
    v_add3_u32 v65, v36, v37, v38
    v_mfma_f32_16x16x32_bf16 v[212:215], v[172:175], a[200:203], v[212:215]
    ds_read_b64_tr_b16 v[108:109], v13 offset:32
    v_xad_u32 v64, v35, v31, v64
    v_mfma_f32_16x16x32_bf16 v[220:223], v[172:175], a[204:207], v[220:223]
    s_waitcnt lgkmcnt(7)
    ds_read_b64_tr_b16 v[110:111], v13 offset:1056
    v_xad_u32 v65, v39, v31, v65
    v_mfma_f32_16x16x32_bf16 v[208:211], v[176:179], a[208:211], v[208:211]
    v_lshl_add_u32 v64, v65, 1, v64
    v_cmp_ne_u32 vcc, v64, v40
    v_mfma_f32_16x16x32_bf16 v[216:219], v[176:179], a[212:215], v[216:219]
    s_cbranch_vccnz L_cold_68
L_back_69:
    v_lshlrev_b32 v48, 16, v32
    v_and_b32 v49, 0xffff0000, v32
    v_mfma_f32_16x16x32_bf16 v[212:215], v[180:183], a[208:211], v[212:215]
    v_lshlrev_b32 v50, 16, v33
    v_and_b32 v51, 0xffff0000, v33
    v_mfma_f32_16x16x32_bf16 v[220:223], v[180:183], a[212:215], v[220:223]
    s_waitcnt lgkmcnt(4)
    v_lshlrev_b32 v52, 16, v34
    v_and_b32 v53, 0xffff0000, v34
    v_mfma_f32_16x16x32_bf16 v[208:211], v[184:187], a[216:219], v[208:211]
    v_lshlrev_b32 v54, 16, v35
    v_and_b32 v55, 0xffff0000, v35
    v_mfma_f32_16x16x32_bf16 v[216:219], v[184:187], a[220:223], v[216:219]
    v_lshlrev_b32 v56, 16, v36
    v_and_b32 v57, 0xffff0000, v36
    v_mfma_f32_16x16x32_bf16 v[212:215], v[188:191], a[216:219], v[212:215]
    v_lshlrev_b32 v58, 16, v37
    v_and_b32 v59, 0xffff0000, v37
    v_mfma_f32_16x16x32_bf16 v[220:223], v[188:191], a[220:223], v[220:223]
    v_lshlrev_b32 v60, 16, v38
    v_and_b32 v61, 0xffff0000, v38
    v_lshlrev_b32 v62, 16, v39
    v_and_b32 v63, 0xffff0000, v39
    s_waitcnt lgkmcnt(0)
    v_lshlrev_b32 v144, 16, v104
    v_and_b32 v145, 0xffff0000, v104
    v_lshlrev_b32 v146, 16, v105
    v_and_b32 v147, 0xffff0000, v105
    v_lshlrev_b32 v148, 16, v106
    v_and_b32 v149, 0xffff0000, v106
    v_lshlrev_b32 v150, 16, v107
    v_and_b32 v151, 0xffff0000, v107
    v_lshlrev_b32 v152, 16, v108
    v_and_b32 v153, 0xffff0000, v108
    v_lshlrev_b32 v154, 16, v109
    v_and_b32 v155, 0xffff0000, v109
    v_lshlrev_b32 v156, 16, v110
    v_and_b32 v157, 0xffff0000, v110
    v_lshlrev_b32 v158, 16, v111
    v_and_b32 v159, 0xffff0000, v111
    v_pk_mul_f32 v[128:129], v[224:225], v[144:145]
    v_pk_mul_f32 v[130:131], v[226:227], v[146:147]
    v_pk_mul_f32 v[132:133], v[228:229], v[148:149]
    v_pk_mul_f32 v[134:135], v[230:231], v[150:151]
    v_pk_mul_f32 v[136:137], v[232:233], v[152:153]
    v_pk_mul_f32 v[138:139], v[234:235], v[154:155]
    v_pk_mul_f32 v[140:141], v[236:237], v[156:157]
    v_pk_mul_f32 v[142:143], v[238:239], v[158:159]
    v_pk_add_f32 v[48:49], v[48:49], v[208:209]
    v_pk_add_f32 v[50:51], v[50:51], v[210:211]
    v_pk_fma_f32 v[128:129], v[48:49], v[242:243], v[128:129] op_sel:[0,0,0] op_sel_hi:[1,0,1]
    v_pk_fma_f32 v[130:131], v[50:51], v[242:243], v[130:131] op_sel:[0,0,0] op_sel_hi:[1,0,1]
    v_cvt_pk_bf16_f32 v64, v128, v129
    v_cvt_pk_bf16_f32 v65, v130, v131
    ds_write_b64 v14, v[64:65] offset:0
    v_pk_add_f32 v[52:53], v[52:53], v[212:213]
    v_pk_add_f32 v[54:55], v[54:55], v[214:215]
    v_pk_fma_f32 v[132:133], v[52:53], v[242:243], v[132:133] op_sel:[0,0,0] op_sel_hi:[1,0,1]
    v_pk_fma_f32 v[134:135], v[54:55], v[242:243], v[134:135] op_sel:[0,0,0] op_sel_hi:[1,0,1]
    v_cvt_pk_bf16_f32 v66, v132, v133
    v_cvt_pk_bf16_f32 v67, v134, v135
    ds_write_b64 v14, v[66:67] offset:32
    ds_read_b128 v[72:75], v15 offset:0
    v_pk_add_f32 v[56:57], v[56:57], v[216:217]
    v_pk_add_f32 v[58:59], v[58:59], v[218:219]
    v_pk_fma_f32 v[136:137], v[56:57], v[242:243], v[136:137] op_sel:[0,1,0] op_sel_hi:[1,1,1]
    v_pk_fma_f32 v[138:139], v[58:59], v[242:243], v[138:139] op_sel:[0,1,0] op_sel_hi:[1,1,1]
    v_cvt_pk_bf16_f32 v68, v136, v137
    v_cvt_pk_bf16_f32 v69, v138, v139
    ds_write_b64 v14, v[68:69] offset:1280
    v_pk_add_f32 v[60:61], v[60:61], v[220:221]
    v_pk_add_f32 v[62:63], v[62:63], v[222:223]
    v_pk_fma_f32 v[140:141], v[60:61], v[242:243], v[140:141] op_sel:[0,1,0] op_sel_hi:[1,1,1]
    v_pk_fma_f32 v[142:143], v[62:63], v[242:243], v[142:143] op_sel:[0,1,0] op_sel_hi:[1,1,1]
    v_cvt_pk_bf16_f32 v70, v140, v141
    v_cvt_pk_bf16_f32 v71, v142, v143
    ds_write_b64 v14, v[70:71] offset:1312
    ds_read_b128 v[76:79], v15 offset:1280
    s_waitcnt lgkmcnt(3)
    buffer_store_dwordx4 v[72:75], v16, s[16:19], s57 offen sc1
    s_waitcnt lgkmcnt(0)
    buffer_store_dwordx4 v[76:79], v16, s[16:19], s12 offen sc1
    s_endpgm
L_cold_1:
    ds_read_b128 v[184:187], v10 offset:0
    ds_read_b128 v[188:191], v10 offset:2048
    ds_read_b128 v[192:195], v12 offset:0
    ds_read_b128 v[196:199], v12 offset:2048
    ds_read_b64 v[240:241], v248 offset:0
    ds_read_b64 v[244:245], v248 offset:2048
    v_xor_b32 v248, 32, v248
    ds_read_b64 v[242:243], v248 offset:0
    ds_read_b64 v[246:247], v248 offset:2048
    s_branch L_back_2
L_cold_3:
    ds_read_b128 v[184:187], v10 offset:32768
    ds_read_b128 v[188:191], v10 offset:34816
    ds_read_b128 v[192:195], v12 offset:32768
    ds_read_b128 v[196:199], v12 offset:34816
    ds_read_b64 v[240:241], v248 offset:32768
    ds_read_b64 v[244:245], v248 offset:34816
    v_xor_b32 v248, 32, v248
    ds_read_b64 v[242:243], v248 offset:32768
    ds_read_b64 v[246:247], v248 offset:34816
    s_branch L_back_4
L_cold_5:
    v_add_u32 v248, 0x10000, v248
    ds_read_b128 v[184:187], v14 offset:0
    ds_read_b128 v[188:191], v14 offset:2048
    ds_read_b128 v[192:195], v16 offset:0
    ds_read_b128 v[196:199], v16 offset:2048
    ds_read_b64 v[240:241], v248 offset:0
    ds_read_b64 v[244:245], v248 offset:2048
    v_xor_b32 v248, 32, v248
    ds_read_b64 v[242:243], v248 offset:0
    ds_read_b64 v[246:247], v248 offset:2048
    s_branch L_back_6
L_cold_7:
    ds_read_b128 v[184:187], v10 offset:0
    ds_read_b128 v[188:191], v10 offset:2048
    ds_read_b128 v[192:195], v12 offset:0
    ds_read_b128 v[196:199], v12 offset:2048
    ds_read_b64 v[240:241], v248 offset:0
    ds_read_b64 v[244:245], v248 offset:2048
    v_xor_b32 v248, 32, v248
    ds_read_b64 v[242:243], v248 offset:0
    ds_read_b64 v[246:247], v248 offset:2048
    s_branch L_back_8
L_cold_9:
    ds_read_b128 v[184:187], v10 offset:32768
    ds_read_b128 v[188:191], v10 offset:34816
    ds_read_b128 v[192:195], v12 offset:32768
    ds_read_b128 v[196:199], v12 offset:34816
    ds_read_b64 v[240:241], v248 offset:32768
    ds_read_b64 v[244:245], v248 offset:34816
    v_xor_b32 v248, 32, v248
    ds_read_b64 v[242:243], v248 offset:32768
    ds_read_b64 v[246:247], v248 offset:34816
    s_branch L_back_10
L_cold_11:
    v_add_u32 v248, 0x10000, v248
    ds_read_b128 v[184:187], v14 offset:0
    ds_read_b128 v[188:191], v14 offset:2048
    ds_read_b128 v[192:195], v16 offset:0
    ds_read_b128 v[196:199], v16 offset:2048
    ds_read_b64 v[240:241], v248 offset:0
    ds_read_b64 v[244:245], v248 offset:2048
    v_xor_b32 v248, 32, v248
    ds_read_b64 v[242:243], v248 offset:0
    ds_read_b64 v[246:247], v248 offset:2048
    s_branch L_back_12
L_cold_13:
    ds_read_b128 v[184:187], v10 offset:0
    ds_read_b128 v[188:191], v10 offset:2048
    ds_read_b128 v[192:195], v12 offset:0
    ds_read_b128 v[196:199], v12 offset:2048
    ds_read_b64 v[240:241], v248 offset:0
    ds_read_b64 v[244:245], v248 offset:2048
    v_xor_b32 v248, 32, v248
    ds_read_b64 v[242:243], v248 offset:0
    ds_read_b64 v[246:247], v248 offset:2048
    s_branch L_back_14
L_cold_16:
    s_mov_b64 exec, 0
    global_atomic_or v232, v234, v30, s[24:25] sc0 sc1
    s_mov_b64 exec, -1
    s_mov_b32 exec_hi, 0
    global_atomic_or v232, v234, v30, s[24:25] sc0 sc1
    s_mov_b64 exec, -1
    s_branch L_ks_15
    s_branch L_back_17
L_cold_19:
    v_cmp_ne_u32 vcc, s3, v232
    s_nop 0
    s_cbranch_vccz L_ks_18
    s_branch L_back_20
L_ks_18:
    s_mov_b32 s100, m0
    s_mov_b32 m0, s47
    s_mov_b32 s101, 2
L_stub4:
    s_cbranch_execz L_tour_back
    s_nop 0
    buffer_load_dwordx4 v29, s[24:27], s41 offen sc1 lds
    buffer_load_dwordx4 v29, s[24:27], s41 offen offset:1024 sc1 lds
    s_mov_b32 m0, s100
    s_branch L_back_20
L_cold_22:
    v_cmp_ne_u32 vcc, s3, v232
    s_nop 0
    s_cbranch_vccz L_ks_21
    s_mov_b32 exec_hi, 0
    global_atomic_or v232, v234, v30, s[24:25] sc0 sc1
    s_mov_b64 exec, -1
    s_branch L_back_23
L_ks_21:
    s_mov_b32 s100, m0
    s_mov_b32 m0, s47
    s_mov_b32 s101, 3
    buffer_load_dwordx4 v29, s[24:27], s41 offen sc1 lds
    buffer_load_dwordx4 v29, s[24:27], s41 offen offset:1024 sc1 lds
    s_mov_b32 m0, s100
    s_branch L_back_23
L_cold_25:
    v_cmp_ne_u32 vcc, s3, v232
    s_nop 0
    s_cbranch_vccz L_ks_24
    s_branch L_back_26
L_ks_24:
    s_mov_b32 s100, m0
    s_mov_b32 m0, s47
    s_mov_b32 s101, 4
    buffer_load_dwordx4 v29, s[24:27], s41 offen sc1 lds
    buffer_load_dwordx4 v29, s[24:27], s41 offen offset:1024 sc1 lds
    s_mov_b32 m0, s100
    s_branch L_back_26
L_cold_27:
    s_cmp_eq_u32 s101, 2
    s_cbranch_scc0 L_kre_30_0
    s_waitcnt vmcnt(12)
    s_branch L_back_28
L_kre_30_0:
    s_cmp_eq_u32 s101, 3
    s_cbranch_scc0 L_kre_30_1
    s_waitcnt vmcnt(9)
    s_branch L_back_28
L_kre_30_1:
    s_cmp_eq_u32 s101, 4
    s_cbranch_scc0 L_kre_30_2
    s_waitcnt vmcnt(4)
    s_branch L_back_28
L_kre_30_2:
    s_mov_b32 s67, 0
L_kre_30:
    v_cmp_ne_u32 vcc, s3, v232
    s_add_u32 s67, s67, 1
    s_cbranch_vccz L_kgo_29
    s_sleep 1
    v_cmp_ne_u32 vcc, s3, v232
    s_add_u32 s67, s67, 1
    s_cbranch_vccz L_kgo_29
    s_sleep 1
    v_cmp_ne_u32 vcc, s3, v232
    s_add_u32 s67, s67, 1
    s_cbranch_vccz L_kgo_29
    s_sleep 1
    v_cmp_ne_u32 vcc, s3, v232
    s_add_u32 s67, s67, 1
    s_cbranch_vccz L_kgo_29
    s_sleep 1
    s_mov_b32 exec_hi, 0
    global_atomic_or v232, v234, v30, s[24:25] sc0 sc1
    s_mov_b64 exec, -1
    s_waitcnt vmcnt(22)
    s_cmp_lt_u32 s67, 65536
    s_cbranch_scc1 L_kre_30
L_kgo_29:
    s_mov_b32 s100, m0
    s_mov_b32 m0, s47
    s_mov_b32 s101, 2
    buffer_load_dwordx4 v29, s[24:27], s41 offen sc1 lds
    buffer_load_dwordx4 v29, s[24:27], s41 offen offset:1024 sc1 lds
    s_mov_b32 m0, s100
    s_waitcnt vmcnt(0)
    s_branch L_back_28
L_cold_31:
    s_mov_b32 s67, 0
L_retry_33:
    s_mov_b32 exec_hi, 0
    global_atomic_or v248, v25, v30, s[24:25] sc0 sc1
    s_mov_b64 exec, -1
    s_sleep 1
    v_cmp_ne_u32 vcc, s3, v248
    s_add_u32 s67, s67, 1
    s_and_b32 s63, vcc_lo, 0x7f
    s_cbranch_scc0 L_back_32
    s_sleep 1
    v_cmp_ne_u32 vcc, s3, v248
    s_add_u32 s67, s67, 1
    s_and_b32 s63, vcc_lo, 0x7f
    s_cbranch_scc0 L_back_32
    s_sleep 1
    v_cmp_ne_u32 vcc, s3, v248
    s_add_u32 s67, s67, 1
    s_and_b32 s63, vcc_lo, 0x7f
    s_cbranch_scc0 L_back_32
    s_sleep 1
    v_cmp_ne_u32 vcc, s3, v248
    s_add_u32 s67, s67, 1
    s_and_b32 s63, vcc_lo, 0x7f
    s_cbranch_scc0 L_back_32
    s_sleep 1
    v_cmp_ne_u32 vcc, s3, v248
    s_add_u32 s67, s67, 1
    s_and_b32 s63, vcc_lo, 0x7f
    s_cbranch_scc0 L_back_32
    s_sleep 1
    v_cmp_ne_u32 vcc, s3, v248
    s_add_u32 s67, s67, 1
    s_and_b32 s63, vcc_lo, 0x7f
    s_cbranch_scc0 L_back_32
    s_waitcnt vmcnt(17)
    s_cmp_lt_u32 s67, 65536
    s_cbranch_scc1 L_retry_33
    s_branch L_back_32
L_cold_34:
    s_mov_b32 s67, 0
L_retry_36:
    s_mov_b32 exec_hi, 0
    global_atomic_or v248, v25, v30, s[24:25] sc0 sc1
    s_mov_b64 exec, -1
    s_sleep 1
    v_cmp_ne_u32 vcc, s3, v248
    s_add_u32 s67, s67, 1
    s_and_b32 s63, vcc_lo, 0x7f00
    s_cbranch_scc0 L_back_35
    s_sleep 1
    v_cmp_ne_u32 vcc, s3, v248
    s_add_u32 s67, s67, 1
    s_and_b32 s63, vcc_lo, 0x7f00
    s_cbranch_scc0 L_back_35
    s_sleep 1
    v_cmp_ne_u32 vcc, s3, v248
    s_add_u32 s67, s67, 1
    s_and_b32 s63, vcc_lo, 0x7f00
    s_cbranch_scc0 L_back_35
    s_sleep 1
    v_cmp_ne_u32 vcc, s3, v248
    s_add_u32 s67, s67, 1
    s_and_b32 s63, vcc_lo, 0x7f00
    s_cbranch_scc0 L_back_35
    s_sleep 1
    v_cmp_ne_u32 vcc, s3, v248
    s_add_u32 s67, s67, 1
    s_and_b32 s63, vcc_lo, 0x7f00
    s_cbranch_scc0 L_back_35
    s_sleep 1
    v_cmp_ne_u32 vcc, s3, v248
    s_add_u32 s67, s67, 1
    s_and_b32 s63, vcc_lo, 0x7f00
    s_cbranch_scc0 L_back_35
    s_waitcnt vmcnt(25)
    s_cmp_lt_u32 s67, 65536
    s_cbranch_scc1 L_retry_36
    s_branch L_back_35
L_cold_37:
    s_mov_b32 s67, 0
L_retry_39:
    s_mov_b32 exec_hi, 0
    global_atomic_or v248, v25, v30, s[24:25] sc0 sc1
    s_mov_b64 exec, -1
    s_sleep 1
    v_cmp_ne_u32 vcc, s3, v248
    s_add_u32 s67, s67, 1
    s_and_b32 s63, vcc_lo, 0x7f0000
    s_cbranch_scc0 L_back_38
    s_sleep 1
    v_cmp_ne_u32 vcc, s3, v248
    s_add_u32 s67, s67, 1
    s_and_b32 s63, vcc_lo, 0x7f0000
    s_cbranch_scc0 L_back_38
    s_sleep 1
    v_cmp_ne_u32 vcc, s3, v248
    s_add_u32 s67, s67, 1
    s_and_b32 s63, vcc_lo, 0x7f0000
    s_cbranch_scc0 L_back_38
    s_sleep 1
    v_cmp_ne_u32 vcc, s3, v248
    s_add_u32 s67, s67, 1
    s_and_b32 s63, vcc_lo, 0x7f0000
    s_cbranch_scc0 L_back_38
    s_sleep 1
    v_cmp_ne_u32 vcc, s3, v248
    s_add_u32 s67, s67, 1
    s_and_b32 s63, vcc_lo, 0x7f0000
    s_cbranch_scc0 L_back_38
    s_sleep 1
    v_cmp_ne_u32 vcc, s3, v248
    s_add_u32 s67, s67, 1
    s_and_b32 s63, vcc_lo, 0x7f0000
    s_cbranch_scc0 L_back_38
    s_waitcnt vmcnt(33)
    s_cmp_lt_u32 s67, 65536
    s_cbranch_scc1 L_retry_39
    s_branch L_back_38
L_cold_44:
    s_mov_b32 s67, 0
L_retry_46:
    s_mov_b32 exec_hi, 0
    global_atomic_or v248, v25, v30, s[24:25] sc0 sc1
    s_mov_b64 exec, -1
    s_sleep 1
    v_cmp_ne_u32 vcc, s3, v248
    s_add_u32 s67, s67, 1
    s_and_b32 s63, vcc_lo, 0x7f000000
    s_cbranch_scc0 L_back_45
    s_sleep 1
    v_cmp_ne_u32 vcc, s3, v248
    s_add_u32 s67, s67, 1
    s_and_b32 s63, vcc_lo, 0x7f000000
    s_cbranch_scc0 L_back_45
    s_sleep 1
    v_cmp_ne_u32 vcc, s3, v248
    s_add_u32 s67, s67, 1
    s_and_b32 s63, vcc_lo, 0x7f000000
    s_cbranch_scc0 L_back_45
    s_sleep 1
    v_cmp_ne_u32 vcc, s3, v248
    s_add_u32 s67, s67, 1
    s_and_b32 s63, vcc_lo, 0x7f000000
    s_cbranch_scc0 L_back_45
    s_sleep 1
    v_cmp_ne_u32 vcc, s3, v248
    s_add_u32 s67, s67, 1
    s_and_b32 s63, vcc_lo, 0x7f000000
    s_cbranch_scc0 L_back_45
    s_sleep 1
    v_cmp_ne_u32 vcc, s3, v248
    s_add_u32 s67, s67, 1
    s_and_b32 s63, vcc_lo, 0x7f000000
    s_cbranch_scc0 L_back_45
    s_waitcnt vmcnt(38)
    s_cmp_lt_u32 s67, 65536
    s_cbranch_scc1 L_retry_46
    s_branch L_back_45
L_cold_47:
    buffer_load_dwordx4 v23, s[24:27], s50 offen sc1 lds
    buffer_load_dwordx4 v23, s[24:27], s51 offen offset:1024 sc1 lds
    s_mov_b32 s64, 1
    s_branch L_back_48
L_cold_49:
    buffer_load_dwordx4 v[32:35], v29, s[24:27], s14 offen offset:0 sc1
    buffer_load_dwordx4 v[36:39], v29, s[24:27], s14 offen offset:1024 sc1
    buffer_load_dword v40, v2, s[24:27], s14 offen offset:2048 sc1
    s_mov_b32 s65, 1
    s_branch L_back_50
L_cold_51:
    buffer_load_dwordx4 v23, s[24:27], s50 offen sc1 lds
    buffer_load_dwordx4 v23, s[24:27], s51 offen offset:1024 sc1 lds
    s_mov_b32 s64, 1
    s_branch L_back_52
L_cold_53:
    s_mov_b32 exec_hi, 1
    global_atomic_or v28, v25, v30, s[24:25] sc0 sc1
    s_mov_b64 exec, -1
    s_branch L_back_54
L_cold_55:
    buffer_load_dwordx4 v[32:35], v29, s[24:27], s14 offen offset:0 sc1
    buffer_load_dwordx4 v[36:39], v29, s[24:27], s14 offen offset:1024 sc1
    buffer_load_dword v40, v2, s[24:27], s14 offen offset:2048 sc1
    s_mov_b32 s65, 1
    s_branch L_back_56
L_cold_57:
    s_lshl_b64 exec, 1, 32
    global_atomic_or v28, v25, v30, s[24:25] sc0 sc1
    s_mov_b64 exec, -1
    s_branch L_back_58
L_cold_59:
    s_lshl_b64 exec, 1, 32
    global_atomic_or v28, v25, v30, s[24:25] sc0 sc1
    s_mov_b64 exec, -1
    s_branch L_back_60
L_cold_61:
    buffer_load_dwordx4 v23, s[24:27], s50 offen sc1 lds
    buffer_load_dwordx4 v23, s[24:27], s51 offen offset:1024 sc1 lds
    s_mov_b32 s64, 1
    s_branch L_back_62
L_cold_63:
    s_mov_b32 s67, 3
L_l_65:
    v_cmp_ne_u32 vcc, s3, v28
    s_or_b32 s62, vcc_lo, s64
    s_cbranch_scc1 L_l_66
    buffer_load_dwordx4 v23, s[24:27], s50 offen sc1 lds
    buffer_load_dwordx4 v23, s[24:27], s51 offen offset:1024 sc1 lds
    s_mov_b32 s64, 1
L_l_66:
    s_or_b32 s62, vcc_hi, s65
    s_cbranch_scc1 L_l_67
    buffer_load_dwordx4 v[32:35], v29, s[24:27], s14 offen offset:0 sc1
    buffer_load_dwordx4 v[36:39], v29, s[24:27], s14 offen offset:1024 sc1
    buffer_load_dword v40, v2, s[24:27], s14 offen offset:2048 sc1
    s_mov_b32 s65, 1
L_l_67:
    s_add_u32 s67, s67, 1
    s_and_b32 s62, s64, s65
    s_cbranch_scc1 L_back_64
    s_and_b32 s62, s67, 3
    s_sleep 1
    s_cbranch_scc1 L_l_65
    s_mov_b32 exec_hi, 1
    global_atomic_or v28, v25, v30, s[24:25] sc0 sc1
    s_mov_b64 exec, -1
    s_cmp_lt_u32 s67, 65536
    s_waitcnt vmcnt(8)
    s_cbranch_scc1 L_l_65
    s_branch L_back_64
L_cold_68:
    s_mov_b32 s67, 0
L_l_70:
    buffer_load_dwordx4 v[32:35], v29, s[24:27], s14 offen offset:0 sc1
    buffer_load_dwordx4 v[36:39], v29, s[24:27], s14 offen offset:1024 sc1
    buffer_load_dword v40, v2, s[24:27], s14 offen offset:2048 sc1
    s_add_u32 s67, s67, 1
    s_waitcnt vmcnt(0)
    v_add3_u32 v64, v32, v33, v34
    v_add3_u32 v65, v36, v37, v38
    v_xad_u32 v64, v35, v31, v64
    v_xad_u32 v65, v39, v31, v65
    v_lshl_add_u32 v64, v65, 1, v64
    v_cmp_ne_u32 vcc, v64, v40
    s_cmp_lt_u32 s67, 16384
    s_cbranch_vccz L_back_69
    s_sleep 2
    s_cbranch_scc1 L_l_70
    s_branch L_back_69
L_exit:
    s_endpgm
L_helper2:
    v_add_u32 v29, 2048, v12
    v_min_u32 v29, 3576, v29
    s_cmp_eq_u32 s4, 3
    s_cselect_b32 s33, 3, 4
    s_lshl_b32 s62, s33, 7
    v_add_u32 v13, s62, v11
    s_mul_i32 s33, s33, 17408
    s_add_u32 m0, s33, s32
    global_load_dwordx2 v[34:35], v29, s[42:43]
    s_mov_b32 exec_lo, 0
    buffer_load_dwordx4 v13, s[12:15], 0 offen lds
    s_mov_b32 exec_lo, -1
    v_mov_b32 v30, 0
    s_mov_b32 s26, 0x1100000
    s_mov_b32 s27, 0x20000
    v_and_b32 v8, 1, v4
    v_lshrrev_b32 v9, 1, v4
    s_lshl_b32 s62, s4, 1
    v_or_b32 v10, s62, v8
    v_bfe_u32 v15, v28, 1, 3
    v_xor_b32 v15, v15, v10
    v_lshlrev_b32 v15, 4, v15
    v_lshl_add_u32 v15, v28, 7, v15
    v_add_u32 v21, 1024, v15
    v_lshlrev_b32 v14, 11, v9
    v_sub_u32 v20, v21, v14
    v_add_u32 v20, 2048, v20
    v_add_u32 v15, -1, v28
    v_bfe_u32 v13, v15, 1, 3
    v_xor_b32 v13, v13, v10
    v_lshlrev_b32 v13, 4, v13
    v_lshl_add_u32 v13, v15, 7, v13
    v_cmp_eq_u32 vcc, 0, v28
    v_mov_b32 v14, 3
    v_lshl_add_u32 v12, v14, 11, v13
    v_add_u32 v12, 1024, v12
    v_lshrrev_b32 v15, 1, v14
    v_add_u32 v15, 2, v15
    v_xor_b32 v15, v15, v10
    v_lshlrev_b32 v15, 4, v15
    v_lshl_add_u32 v15, v14, 7, v15
    v_add_u32 v15, 512, v15
    v_cndmask_b32 v12, v12, v15, vcc
    v_sub_u32 v14, 3, v9
    v_lshl_add_u32 v22, v14, 11, v13
    v_add_u32 v22, 1024, v22
    v_lshrrev_b32 v15, 1, v14
    v_add_u32 v15, 2, v15
    v_xor_b32 v15, v15, v10
    v_lshlrev_b32 v15, 4, v15
    v_lshl_add_u32 v15, v14, 7, v15
    v_add_u32 v15, 512, v15
    v_cndmask_b32 v22, v22, v15, vcc
    v_sub_u32 v14, 2, v9
    v_lshl_add_u32 v23, v14, 11, v13
    v_add_u32 v23, 1024, v23
    v_lshrrev_b32 v15, 1, v14
    v_add_u32 v15, 2, v15
    v_xor_b32 v15, v15, v10
    v_lshlrev_b32 v15, 4, v15
    v_lshl_add_u32 v15, v14, 7, v15
    v_add_u32 v15, 512, v15
    v_cndmask_b32 v23, v23, v15, vcc
    s_mov_b32 exec_lo, 0
    v_mov_b32 v21, v12
    s_mov_b32 exec_lo, -1
    v_lshrrev_b32 v14, 3, v28
    v_cmp_eq_u32 vcc, v14, v8
    v_and_b32 v14, 1, v1
    v_lshlrev_b32 v14, 4, v14
    v_mov_b32 v15, 0xffff
    v_lshlrev_b32 v14, v14, v15
    v_cndmask_b32 v14, 0, v14, vcc
    v_bfe_u32 v15, v1, 1, 2
    v_cmp_eq_u32 vcc, 0, v15
    s_nop 1
    v_cndmask_b32 v16, 0, v14, vcc
    v_cmp_eq_u32 vcc, 1, v15
    s_nop 1
    v_cndmask_b32 v17, 0, v14, vcc
    v_cmp_eq_u32 vcc, 2, v15
    s_nop 1
    v_cndmask_b32 v18, 0, v14, vcc
    v_cmp_eq_u32 vcc, 3, v15
    s_nop 1
    v_cndmask_b32 v19, 0, v14, vcc
    v_cmp_gt_u32 vcc, 32, v1
    v_mov_b32 v14, 0x3f803f80
    s_nop 0
    v_cndmask_b32 v14, 0, v14, vcc
    v_and_b32 v24, v14, v16
    v_and_b32 v25, v14, v17
    v_and_b32 v26, v14, v18
    v_and_b32 v27, v14, v19
    v_xor_b32 v14, 0x3f803f80, v14
    v_and_b32 v60, v14, v16
    v_and_b32 v61, v14, v17
    v_and_b32 v62, v14, v18
    v_and_b32 v63, v14, v19
    v_mov_b32 v14, 0x03020302
    v_mov_b32 v15, 0x01000100
    v_cndmask_b32 v14, v14, v15, vcc
    s_mul_i32 s62, s4, 2304
    s_add_u32 s62, s62, 121856
    v_mul_u32_u24 v9, 144, v28
    v_lshlrev_b32 v15, 5, v4
    v_sub_u32 v9, v9, v15
    v_add_u32 v9, s62, v9
    v_add_u32 v9, 96, v9
    v_mul_u32_u24 v10, 144, v5
    v_lshl_add_u32 v10, v7, 4, v10
    v_add_u32 v10, s62, v10
    v_lshlrev_b32 v8, 12, v5
    v_lshl_add_u32 v8, v7, 4, v8
    s_lshl_b32 s62, s4, 16
    s_lshl_b32 s63, s2, 7
    s_sub_u32 s62, s62, s63
    s_add_u32 s40, s62, 0x40f80
    s_add_u32 s41, s40, 0x8000
    s_lshl_b32 s62, s4, 13
    s_lshl_b32 s63, s2, 2
    s_add_u32 s62, s62, s63
    s_add_u32 s44, s62, 0xf00100
    v_lshlrev_b32 v45, 15, v5
    v_lshl_add_u32 v45, v7, 10, v45
    v_add_u32 v36, 52224, v20
    v_add_u32 v40, 104448, v20
    v_add_u32 v37, 52224, v21
    v_add_u32 v41, 104448, v21
    v_add_u32 v38, 52224, v22
    v_add_u32 v42, 104448, v22
    v_add_u32 v39, 52224, v23
    v_add_u32 v43, 104448, v23
    v_lshlrev_b32 v44, 2, v28
    s_waitcnt vmcnt(10)
    ds_bpermute_b32 v46, v44, v32 offset:0
    ds_bpermute_b32 v47, v44, v33 offset:0
    ds_bpermute_b32 v48, v44, v32 offset:64
    ds_bpermute_b32 v49, v44, v33 offset:64
    ds_bpermute_b32 v50, v44, v32 offset:128
    ds_bpermute_b32 v51, v44, v33 offset:128
    ds_bpermute_b32 v52, v44, v32 offset:192
    ds_bpermute_b32 v53, v44, v33 offset:192
    s_add_u32 m0, s28, 35584
    s_nop 0
    buffer_load_dwordx4 v2, s[12:15], s29 offen offset:256 nt lds
    buffer_load_dwordx4 v3, s[12:15], s30 offen offset:1280 nt lds
    s_add_u32 m0, s28, 43776
    s_nop 0
    buffer_load_dwordx4 v2, s[16:19], s29 offen offset:256 nt lds
    buffer_load_dwordx4 v3, s[16:19], s30 offen offset:1280 nt lds
    s_waitcnt lgkmcnt(0)
    v_perm_b32 v15, v46, v46, v14
    v_and_b32 v64, v15, v16
    v_and_b32 v65, v15, v17
    v_and_b32 v66, v15, v18
    v_and_b32 v67, v15, v19
    v_perm_b32 v15, v47, v47, v14
    v_and_b32 v68, v15, v16
    v_and_b32 v69, v15, v17
    v_and_b32 v70, v15, v18
    v_and_b32 v71, v15, v19
    s_mul_i32 s3, s3, 1664525
    s_add_u32 s3, s3, 1013904223
    s_max_u32 s3, s3, 1
    s_waitcnt vmcnt(10)
    s_barrier
    ds_read_b128 a[64:67], v20 offset:4096
    ds_read_b128 a[68:71], v20 offset:12288
    ds_read_b128 a[72:75], v20 offset:0
    ds_read_b128 a[76:79], v20 offset:2048
    ds_read_b128 a[80:83], v21 offset:0
    ds_read_b128 a[84:87], v20 offset:8192
    ds_read_b128 a[88:91], v22 offset:0
    ds_read_b128 a[92:95], v23 offset:0
    s_add_u32 m0, s28, 52864
    s_nop 0
    buffer_load_dwordx4 v2, s[12:15], s29 offen offset:384 nt lds
    buffer_load_dwordx4 v3, s[12:15], s30 offen offset:1408 nt lds
    s_add_u32 m0, s28, 61056
    s_nop 0
    buffer_load_dwordx4 v2, s[16:19], s29 offen offset:384 nt lds
    buffer_load_dwordx4 v3, s[16:19], s30 offen offset:1408 nt lds
    v_perm_b32 v15, v48, v48, v14
    v_and_b32 v72, v15, v16
    v_and_b32 v73, v15, v17
    v_and_b32 v74, v15, v18
    v_and_b32 v75, v15, v19
    v_perm_b32 v15, v49, v49, v14
    v_and_b32 v76, v15, v16
    v_and_b32 v77, v15, v17
    v_and_b32 v78, v15, v18
    v_and_b32 v79, v15, v19
    s_waitcnt lgkmcnt(7)
    v_mfma_f32_16x16x32_bf16 v[184:187], a[64:67], v[64:67], 0
    s_waitcnt lgkmcnt(6)
    v_perm_b32 v15, v50, v50, v14
    v_and_b32 v80, v15, v16
    v_mfma_f32_16x16x32_bf16 v[188:191], a[68:71], v[24:27], 0
    s_waitcnt lgkmcnt(5)
    v_and_b32 v81, v15, v17
    v_and_b32 v82, v15, v18
    v_mfma_f32_16x16x32_bf16 v[184:187], a[72:75], v[68:71], v[184:187]
    s_waitcnt lgkmcnt(4)
    v_and_b32 v83, v15, v19
    v_perm_b32 v15, v51, v51, v14
    v_mfma_f32_16x16x32_bf16 v[176:179], a[76:79], v[64:67], 0
    v_and_b32 v84, v15, v16
    v_and_b32 v85, v15, v17
    v_mfma_f32_16x16x32_bf16 v[180:183], a[68:71], v[60:63], 0
    s_waitcnt lgkmcnt(3)
    v_and_b32 v86, v15, v18
    v_and_b32 v87, v15, v19
    v_mfma_f32_16x16x32_bf16 v[176:179], a[80:83], v[68:71], v[176:179]
    v_mul_f32 v184, v184, v188
    v_mul_f32 v185, v185, v189
    v_mfma_f32_16x16x32_bf16 v[168:171], a[72:75], v[64:67], 0
    s_waitcnt lgkmcnt(2)
    v_mul_f32 v186, v186, v190
    v_mul_f32 v187, v187, v191
    v_mfma_f32_16x16x32_bf16 v[172:175], a[84:87], v[24:27], 0
    s_waitcnt lgkmcnt(1)
    v_mul_f32 v176, v176, v180
    v_mul_f32 v177, v177, v181
    v_mfma_f32_16x16x32_bf16 v[168:171], a[88:91], v[68:71], v[168:171]
    v_mul_f32 v178, v178, v182
    v_mul_f32 v179, v179, v183
    v_mfma_f32_16x16x32_bf16 v[160:163], a[80:83], v[64:67], 0
    v_cvt_pk_bf16_f32 v224, v187, v179
    v_cvt_pk_bf16_f32 v226, v186, v178
    v_mfma_f32_16x16x32_bf16 v[164:167], a[84:87], v[60:63], 0
    s_waitcnt lgkmcnt(0)
    v_cvt_pk_bf16_f32 v228, v185, v177
    v_cvt_pk_bf16_f32 v230, v184, v176
    v_mfma_f32_16x16x32_bf16 v[160:163], a[92:95], v[68:71], v[160:163]
    v_mul_f32 v168, v168, v172
    v_mul_f32 v169, v169, v173
    v_perm_b32 v15, v52, v52, v14
    v_and_b32 v88, v15, v16
    v_and_b32 v89, v15, v17
    v_and_b32 v90, v15, v18
    v_and_b32 v91, v15, v19
    v_perm_b32 v15, v53, v53, v14
    v_and_b32 v92, v15, v16
    v_and_b32 v93, v15, v17
    v_and_b32 v94, v15, v18
    v_and_b32 v95, v15, v19
    s_waitcnt vmcnt(10)
    s_barrier
    ds_read_b128 a[96:99], v20 offset:21504
    ds_read_b128 a[100:103], v20 offset:29696
    ds_read_b128 a[104:107], v20 offset:17408
    ds_read_b128 a[108:111], v20 offset:19456
    ds_read_b128 a[112:115], v21 offset:17408
    ds_read_b128 a[116:119], v20 offset:25600
    ds_read_b128 a[120:123], v22 offset:17408
    ds_read_b128 a[124:127], v23 offset:17408
    s_add_u32 m0, s28, 70144
    s_nop 0
    buffer_load_dwordx4 v2, s[12:15], s29 offen offset:512 nt lds
    buffer_load_dwordx4 v3, s[12:15], s30 offen offset:1536 nt lds
    s_add_u32 m0, s28, 78336
    s_nop 0
    buffer_load_dwordx4 v2, s[16:19], s29 offen offset:512 nt lds
    buffer_load_dwordx4 v3, s[16:19], s30 offen offset:1536 nt lds
    s_waitcnt lgkmcnt(7)
    v_mfma_f32_16x16x32_bf16 v[216:219], a[96:99], v[72:75], 0
    s_waitcnt lgkmcnt(6)
    v_mul_f32 v170, v170, v174
    v_mul_f32 v171, v171, v175
    v_mfma_f32_16x16x32_bf16 v[220:223], a[100:103], v[24:27], 0
    s_waitcnt lgkmcnt(5)
    v_mul_f32 v160, v160, v164
    v_mul_f32 v161, v161, v165
    v_mfma_f32_16x16x32_bf16 v[216:219], a[104:107], v[76:79], v[216:219]
    s_waitcnt lgkmcnt(4)
    v_mul_f32 v162, v162, v166
    v_mul_f32 v163, v163, v167
    v_mfma_f32_16x16x32_bf16 v[208:211], a[108:111], v[72:75], 0
    v_cvt_pk_bf16_f32 v225, v171, v163
    v_cvt_pk_bf16_f32 v227, v170, v162
    v_mfma_f32_16x16x32_bf16 v[212:215], a[100:103], v[60:63], 0
    s_waitcnt lgkmcnt(3)
    v_cvt_pk_bf16_f32 v229, v169, v161
    v_cvt_pk_bf16_f32 v231, v168, v160
    v_mfma_f32_16x16x32_bf16 v[208:211], a[112:115], v[76:79], v[208:211]
    ds_write_b128 v9, v[224:227] offset:0
    v_mul_f32 v216, v216, v220
    v_mul_f32 v217, v217, v221
    v_mfma_f32_16x16x32_bf16 v[200:203], a[104:107], v[72:75], 0
    s_waitcnt lgkmcnt(3)
    ds_write_b128 v9, v[228:231] offset:16
    v_mul_f32 v218, v218, v222
    v_mul_f32 v219, v219, v223
    v_mfma_f32_16x16x32_bf16 v[204:207], a[116:119], v[24:27], 0
    s_waitcnt lgkmcnt(3)
    ds_read_b128 a[0:3], v10
    v_mul_f32 v208, v208, v212
    v_mul_f32 v209, v209, v213
    v_mfma_f32_16x16x32_bf16 v[200:203], a[120:123], v[76:79], v[200:203]
    ds_read_b128 a[4:7], v10 offset:1152
    v_mul_f32 v210, v210, v214
    v_mul_f32 v211, v211, v215
    v_mfma_f32_16x16x32_bf16 v[192:195], a[112:115], v[72:75], 0
    v_cvt_pk_bf16_f32 v232, v219, v211
    v_cvt_pk_bf16_f32 v234, v218, v210
    v_mfma_f32_16x16x32_bf16 v[196:199], a[116:119], v[60:63], 0
    s_waitcnt lgkmcnt(4)
    v_cvt_pk_bf16_f32 v236, v217, v209
    v_cvt_pk_bf16_f32 v238, v216, v208
    v_mfma_f32_16x16x32_bf16 v[192:195], a[124:127], v[76:79], v[192:195]
    v_mul_f32 v200, v200, v204
    v_mul_f32 v201, v201, v205
    s_waitcnt vmcnt(13)
    ds_bpermute_b32 v54, v44, v34 offset:0
    ds_bpermute_b32 v55, v44, v35 offset:0
    ds_bpermute_b32 v56, v44, v34 offset:64
    ds_bpermute_b32 v57, v44, v35 offset:64
    ds_bpermute_b32 v58, v44, v34 offset:128
    ds_bpermute_b32 v59, v44, v35 offset:128
    s_waitcnt lgkmcnt(0)
    v_perm_b32 v15, v54, v54, v14
    v_and_b32 v96, v15, v16
    v_and_b32 v97, v15, v17
    v_and_b32 v98, v15, v18
    v_and_b32 v99, v15, v19
    v_perm_b32 v15, v55, v55, v14
    v_and_b32 v100, v15, v16
    v_and_b32 v101, v15, v17
    v_and_b32 v102, v15, v18
    v_and_b32 v103, v15, v19
    v_perm_b32 v15, v56, v56, v14
    v_and_b32 v104, v15, v16
    v_and_b32 v105, v15, v17
    v_and_b32 v106, v15, v18
    v_and_b32 v107, v15, v19
    v_perm_b32 v15, v57, v57, v14
    v_and_b32 v108, v15, v16
    v_and_b32 v109, v15, v17
    v_and_b32 v110, v15, v18
    v_and_b32 v111, v15, v19
    v_perm_b32 v15, v58, v58, v14
    v_and_b32 v112, v15, v16
    v_and_b32 v113, v15, v17
    v_and_b32 v114, v15, v18
    v_and_b32 v115, v15, v19
    v_perm_b32 v15, v59, v59, v14
    v_and_b32 v116, v15, v16
    v_and_b32 v117, v15, v17
    v_and_b32 v118, v15, v18
    v_and_b32 v119, v15, v19
    s_waitcnt vmcnt(8)
    s_barrier
    ds_read_b128 a[64:67], v20 offset:38912
    ds_read_b128 a[68:71], v20 offset:47104
    ds_read_b128 a[72:75], v20 offset:34816
    ds_read_b128 a[76:79], v20 offset:36864
    ds_read_b128 a[80:83], v21 offset:34816
    ds_read_b128 a[84:87], v20 offset:43008
    ds_read_b128 a[88:91], v22 offset:34816
    ds_read_b128 a[92:95], v23 offset:34816
    s_add_u32 m0, s28, 87424
    s_nop 0
    buffer_load_dwordx4 v2, s[12:15], s29 offen offset:640 nt lds
    buffer_load_dwordx4 v3, s[12:15], s30 offen offset:1664 nt lds
    s_add_u32 m0, s28, 95616
    s_nop 0
    buffer_load_dwordx4 v2, s[16:19], s29 offen offset:640 nt lds
    buffer_load_dwordx4 v3, s[16:19], s30 offen offset:1664 nt lds
    s_waitcnt lgkmcnt(7)
    v_mfma_f32_16x16x32_bf16 v[184:187], a[64:67], v[80:83], 0
    s_waitcnt lgkmcnt(6)
    v_mul_f32 v202, v202, v206
    v_mul_f32 v203, v203, v207
    v_mfma_f32_16x16x32_bf16 v[188:191], a[68:71], v[24:27], 0
    s_waitcnt lgkmcnt(5)
    v_mul_f32 v192, v192, v196
    v_mul_f32 v193, v193, v197
    v_mfma_f32_16x16x32_bf16 v[184:187], a[72:75], v[84:87], v[184:187]
    s_waitcnt lgkmcnt(4)
    v_mul_f32 v194, v194, v198
    v_mul_f32 v195, v195, v199
    v_mfma_f32_16x16x32_bf16 v[176:179], a[76:79], v[80:83], 0
    v_cvt_pk_bf16_f32 v233, v203, v195
    v_cvt_pk_bf16_f32 v235, v202, v194
    v_mfma_f32_16x16x32_bf16 v[180:183], a[68:71], v[60:63], 0
    s_waitcnt lgkmcnt(3)
    v_cvt_pk_bf16_f32 v237, v201, v193
    v_cvt_pk_bf16_f32 v239, v200, v192
    v_mfma_f32_16x16x32_bf16 v[176:179], a[80:83], v[84:87], v[176:179]
    ds_write_b128 v9, v[232:235] offset:0
    v_mul_f32 v184, v184, v188
    v_mul_f32 v185, v185, v189
    v_mfma_f32_16x16x32_bf16 v[168:171], a[72:75], v[80:83], 0
    s_waitcnt lgkmcnt(3)
    ds_write_b128 v9, v[236:239] offset:16
    v_mul_f32 v186, v186, v190
    v_mul_f32 v187, v187, v191
    v_mfma_f32_16x16x32_bf16 v[172:175], a[84:87], v[24:27], 0
    s_waitcnt lgkmcnt(3)
    ds_read_b128 a[8:11], v10
    v_mul_f32 v176, v176, v180
    v_mul_f32 v177, v177, v181
    v_mfma_f32_16x16x32_bf16 v[168:171], a[88:91], v[84:87], v[168:171]
    ds_read_b128 a[12:15], v10 offset:1152
    v_mul_f32 v178, v178, v182
    v_mul_f32 v179, v179, v183
    v_mfma_f32_16x16x32_bf16 v[160:163], a[80:83], v[80:83], 0
    v_cvt_pk_bf16_f32 v224, v187, v179
    v_cvt_pk_bf16_f32 v226, v186, v178
    v_mfma_f32_16x16x32_bf16 v[164:167], a[84:87], v[60:63], 0
    s_waitcnt lgkmcnt(4)
    v_cvt_pk_bf16_f32 v228, v185, v177
    v_cvt_pk_bf16_f32 v230, v184, v176
    v_mfma_f32_16x16x32_bf16 v[160:163], a[92:95], v[84:87], v[160:163]
    v_mul_f32 v168, v168, v172
    v_mul_f32 v169, v169, v173
    s_waitcnt vmcnt(8)
    s_barrier
    ds_read_b128 a[96:99], v36 offset:4096
    ds_read_b128 a[100:103], v36 offset:12288
    ds_read_b128 a[104:107], v36 offset:0
    ds_read_b128 a[108:111], v36 offset:2048
    ds_read_b128 a[112:115], v37 offset:0
    ds_read_b128 a[116:119], v36 offset:8192
    ds_read_b128 a[120:123], v38 offset:0
    ds_read_b128 a[124:127], v39 offset:0
    s_add_u32 m0, s28, 104704
    s_nop 0
    buffer_load_dwordx4 v2, s[12:15], s29 offen offset:768 nt lds
    buffer_load_dwordx4 v3, s[12:15], s30 offen offset:1792 nt lds
    s_add_u32 m0, s28, 112896
    s_nop 0
    buffer_load_dwordx4 v2, s[16:19], s29 offen offset:768 nt lds
    buffer_load_dwordx4 v3, s[16:19], s30 offen offset:1792 nt lds
    s_waitcnt lgkmcnt(7)
    v_mfma_f32_16x16x32_bf16 v[216:219], a[96:99], v[88:91], 0
    s_waitcnt lgkmcnt(6)
    v_mul_f32 v170, v170, v174
    v_mul_f32 v171, v171, v175
    v_mfma_f32_16x16x32_bf16 v[220:223], a[100:103], v[24:27], 0
    s_waitcnt lgkmcnt(5)
    buffer_store_dwordx4 a[0:3], v8, s[24:27], s40 offen sc1
    v_mul_f32 v160, v160, v164
    v_mul_f32 v161, v161, v165
    v_mfma_f32_16x16x32_bf16 v[216:219], a[104:107], v[92:95], v[216:219]
    s_waitcnt lgkmcnt(4)
    v_mul_f32 v162, v162, v166
    v_mul_f32 v163, v163, v167
    v_mfma_f32_16x16x32_bf16 v[208:211], a[108:111], v[88:91], 0
    s_add_u32 s40, s40, 0x40000
    v_cvt_pk_bf16_f32 v225, v171, v163
    v_cvt_pk_bf16_f32 v227, v170, v162
    v_mfma_f32_16x16x32_bf16 v[212:215], a[100:103], v[60:63], 0
    s_waitcnt lgkmcnt(3)
    buffer_store_dwordx4 a[4:7], v8, s[24:27], s41 offen sc1
    v_cvt_pk_bf16_f32 v229, v169, v161
    v_cvt_pk_bf16_f32 v231, v168, v160
    v_mfma_f32_16x16x32_bf16 v[208:211], a[112:115], v[92:95], v[208:211]
    s_add_u32 s41, s41, 0x40000
    ds_write_b128 v9, v[224:227] offset:0
    v_mul_f32 v216, v216, v220
    v_mul_f32 v217, v217, v221
    v_mfma_f32_16x16x32_bf16 v[200:203], a[104:107], v[88:91], 0
    s_waitcnt lgkmcnt(3)
    ds_write_b128 v9, v[228:231] offset:16
    v_mul_f32 v218, v218, v222
    v_mul_f32 v219, v219, v223
    v_mfma_f32_16x16x32_bf16 v[204:207], a[116:119], v[24:27], 0
    s_waitcnt lgkmcnt(3)
    ds_read_b128 a[16:19], v10
    v_mul_f32 v208, v208, v212
    v_mul_f32 v209, v209, v213
    v_mfma_f32_16x16x32_bf16 v[200:203], a[120:123], v[92:95], v[200:203]
    ds_read_b128 a[20:23], v10 offset:1152
    v_mul_f32 v210, v210, v214
    v_mul_f32 v211, v211, v215
    v_mfma_f32_16x16x32_bf16 v[192:195], a[112:115], v[88:91], 0
    v_cvt_pk_bf16_f32 v232, v219, v211
    v_cvt_pk_bf16_f32 v234, v218, v210
    v_mfma_f32_16x16x32_bf16 v[196:199], a[116:119], v[60:63], 0
    s_waitcnt lgkmcnt(4)
    v_cvt_pk_bf16_f32 v236, v217, v209
    v_cvt_pk_bf16_f32 v238, v216, v208
    v_mfma_f32_16x16x32_bf16 v[192:195], a[124:127], v[92:95], v[192:195]
    v_mul_f32 v200, v200, v204
    v_mul_f32 v201, v201, v205
    s_waitcnt vmcnt(10)
    s_barrier
    ds_read_b128 a[64:67], v36 offset:21504
    ds_read_b128 a[68:71], v36 offset:29696
    ds_read_b128 a[72:75], v36 offset:17408
    ds_read_b128 a[76:79], v36 offset:19456
    ds_read_b128 a[80:83], v37 offset:17408
    ds_read_b128 a[84:87], v36 offset:25600
    ds_read_b128 a[88:91], v38 offset:17408
    ds_read_b128 a[92:95], v39 offset:17408
    s_waitcnt lgkmcnt(7)
    v_mfma_f32_16x16x32_bf16 v[184:187], a[64:67], v[96:99], 0
    s_waitcnt lgkmcnt(6)
    v_mul_f32 v202, v202, v206
    v_mul_f32 v203, v203, v207
    v_mfma_f32_16x16x32_bf16 v[188:191], a[68:71], v[24:27], 0
    s_waitcnt lgkmcnt(5)
    buffer_store_dwordx4 a[8:11], v8, s[24:27], s40 offen sc1
    v_mul_f32 v192, v192, v196
    v_mul_f32 v193, v193, v197
    v_mfma_f32_16x16x32_bf16 v[184:187], a[72:75], v[100:103], v[184:187]
    s_waitcnt lgkmcnt(4)
    v_mul_f32 v194, v194, v198
    v_mul_f32 v195, v195, v199
    v_mfma_f32_16x16x32_bf16 v[176:179], a[76:79], v[96:99], 0
    s_add_u32 s40, s40, 0x40000
    v_cvt_pk_bf16_f32 v233, v203, v195
    v_cvt_pk_bf16_f32 v235, v202, v194
    v_mfma_f32_16x16x32_bf16 v[180:183], a[68:71], v[60:63], 0
    s_waitcnt lgkmcnt(3)
    buffer_store_dwordx4 a[12:15], v8, s[24:27], s41 offen sc1
    v_cvt_pk_bf16_f32 v237, v201, v193
    v_cvt_pk_bf16_f32 v239, v200, v192
    v_mfma_f32_16x16x32_bf16 v[176:179], a[80:83], v[100:103], v[176:179]
    s_add_u32 s41, s41, 0x40000
    ds_write_b128 v9, v[232:235] offset:0
    v_mul_f32 v184, v184, v188
    v_mul_f32 v185, v185, v189
    v_mfma_f32_16x16x32_bf16 v[168:171], a[72:75], v[96:99], 0
    s_waitcnt lgkmcnt(3)
    ds_write_b128 v9, v[236:239] offset:16
    v_mul_f32 v186, v186, v190
    v_mul_f32 v187, v187, v191
    v_mfma_f32_16x16x32_bf16 v[172:175], a[84:87], v[24:27], 0
    s_waitcnt lgkmcnt(3)
    ds_read_b128 a[24:27], v10
    buffer_store_dwordx4 a[16:19], v8, s[24:27], s40 offen sc1
    v_mul_f32 v176, v176, v180
    v_mul_f32 v177, v177, v181
    v_mfma_f32_16x16x32_bf16 v[168:171], a[88:91], v[100:103], v[168:171]
    s_add_u32 s40, s40, 0x40000
    ds_read_b128 a[28:31], v10 offset:1152
    v_mul_f32 v178, v178, v182
    v_mul_f32 v179, v179, v183
    v_mfma_f32_16x16x32_bf16 v[160:163], a[80:83], v[96:99], 0
    v_cvt_pk_bf16_f32 v224, v187, v179
    v_cvt_pk_bf16_f32 v226, v186, v178
    v_mfma_f32_16x16x32_bf16 v[164:167], a[84:87], v[60:63], 0
    s_waitcnt lgkmcnt(4)
    buffer_store_dwordx4 a[20:23], v8, s[24:27], s41 offen sc1
    v_cvt_pk_bf16_f32 v228, v185, v177
    v_cvt_pk_bf16_f32 v230, v184, v176
    v_mfma_f32_16x16x32_bf16 v[160:163], a[92:95], v[100:103], v[160:163]
    s_add_u32 s41, s41, 0x40000
    v_mul_f32 v168, v168, v172
    v_mul_f32 v169, v169, v173
    s_waitcnt vmcnt(10)
    s_barrier
    ds_read_b128 a[96:99], v36 offset:38912
    ds_read_b128 a[100:103], v36 offset:47104
    ds_read_b128 a[104:107], v36 offset:34816
    ds_read_b128 a[108:111], v36 offset:36864
    ds_read_b128 a[112:115], v37 offset:34816
    ds_read_b128 a[116:119], v36 offset:43008
    ds_read_b128 a[120:123], v38 offset:34816
    ds_read_b128 a[124:127], v39 offset:34816
    s_waitcnt lgkmcnt(7)
    v_mfma_f32_16x16x32_bf16 v[216:219], a[96:99], v[104:107], 0
    s_waitcnt lgkmcnt(6)
    v_mul_f32 v170, v170, v174
    v_mul_f32 v171, v171, v175
    v_mfma_f32_16x16x32_bf16 v[220:223], a[100:103], v[24:27], 0
    s_waitcnt lgkmcnt(5)
    buffer_store_dwordx4 a[24:27], v8, s[24:27], s40 offen sc1
    v_mul_f32 v160, v160, v164
    v_mul_f32 v161, v161, v165
    v_mfma_f32_16x16x32_bf16 v[216:219], a[104:107], v[108:111], v[216:219]
    s_waitcnt lgkmcnt(4)
    v_mul_f32 v162, v162, v166
    v_mul_f32 v163, v163, v167
    v_mfma_f32_16x16x32_bf16 v[208:211], a[108:111], v[104:107], 0
    s_add_u32 s40, s40, 0x40000
    v_cvt_pk_bf16_f32 v225, v171, v163
    v_cvt_pk_bf16_f32 v227, v170, v162
    v_mfma_f32_16x16x32_bf16 v[212:215], a[100:103], v[60:63], 0
    s_waitcnt lgkmcnt(3)
    buffer_store_dwordx4 a[28:31], v8, s[24:27], s41 offen sc1
    v_cvt_pk_bf16_f32 v229, v169, v161
    v_cvt_pk_bf16_f32 v231, v168, v160
    v_mfma_f32_16x16x32_bf16 v[208:211], a[112:115], v[108:111], v[208:211]
    s_add_u32 s41, s41, 0x40000
    ds_write_b128 v9, v[224:227] offset:0
    v_mul_f32 v216, v216, v220
    v_mul_f32 v217, v217, v221
    v_mfma_f32_16x16x32_bf16 v[200:203], a[104:107], v[104:107], 0
    s_waitcnt lgkmcnt(3)
    ds_write_b128 v9, v[228:231] offset:16
    v_mul_f32 v218, v218, v222
    v_mul_f32 v219, v219, v223
    v_mfma_f32_16x16x32_bf16 v[204:207], a[116:119], v[24:27], 0
    s_waitcnt lgkmcnt(3)
    ds_read_b128 a[32:35], v10
    v_mul_f32 v208, v208, v212
    v_mul_f32 v209, v209, v213
    v_mfma_f32_16x16x32_bf16 v[200:203], a[120:123], v[108:111], v[200:203]
    ds_read_b128 a[36:39], v10 offset:1152
    v_mul_f32 v210, v210, v214
    v_mul_f32 v211, v211, v215
    v_mfma_f32_16x16x32_bf16 v[192:195], a[112:115], v[104:107], 0
    v_cvt_pk_bf16_f32 v232, v219, v211
    v_cvt_pk_bf16_f32 v234, v218, v210
    v_mfma_f32_16x16x32_bf16 v[196:199], a[116:119], v[60:63], 0
    s_waitcnt lgkmcnt(4)
    v_cvt_pk_bf16_f32 v236, v217, v209
    v_cvt_pk_bf16_f32 v238, v216, v208
    v_mfma_f32_16x16x32_bf16 v[192:195], a[124:127], v[108:111], v[192:195]
    v_mul_f32 v200, v200, v204
    v_mul_f32 v201, v201, v205
    s_waitcnt vmcnt(8)
    s_barrier
    ds_read_b128 a[64:67], v40 offset:4096
    ds_read_b128 a[68:71], v40 offset:12288
    ds_read_b128 a[72:75], v40 offset:0
    ds_read_b128 a[76:79], v40 offset:2048
    ds_read_b128 a[80:83], v41 offset:0
    ds_read_b128 a[84:87], v40 offset:8192
    ds_read_b128 a[88:91], v42 offset:0
    ds_read_b128 a[92:95], v43 offset:0
    s_waitcnt lgkmcnt(7)
    v_mfma_f32_16x16x32_bf16 v[184:187], a[64:67], v[112:115], 0
    s_waitcnt lgkmcnt(6)
    v_mul_f32 v202, v202, v206
    v_mul_f32 v203, v203, v207
    v_mfma_f32_16x16x32_bf16 v[188:191], a[68:71], v[24:27], 0
    s_waitcnt lgkmcnt(5)
    buffer_store_dwordx4 a[32:35], v8, s[24:27], s40 offen sc1
    v_mul_f32 v192, v192, v196
    v_mul_f32 v193, v193, v197
    v_mfma_f32_16x16x32_bf16 v[184:187], a[72:75], v[116:119], v[184:187]
    s_waitcnt lgkmcnt(4)
    v_mul_f32 v194, v194, v198
    v_mul_f32 v195, v195, v199
    v_mfma_f32_16x16x32_bf16 v[176:179], a[76:79], v[112:115], 0
    s_add_u32 s40, s40, 0x40000
    v_cvt_pk_bf16_f32 v233, v203, v195
    v_cvt_pk_bf16_f32 v235, v202, v194
    v_mfma_f32_16x16x32_bf16 v[180:183], a[68:71], v[60:63], 0
    s_waitcnt lgkmcnt(3)
    buffer_store_dwordx4 a[36:39], v8, s[24:27], s41 offen sc1
    v_cvt_pk_bf16_f32 v237, v201, v193
    v_cvt_pk_bf16_f32 v239, v200, v192
    v_mfma_f32_16x16x32_bf16 v[176:179], a[80:83], v[116:119], v[176:179]
    s_add_u32 s41, s41, 0x40000
    ds_write_b128 v9, v[232:235] offset:0
    v_mul_f32 v184, v184, v188
    v_mul_f32 v185, v185, v189
    v_mfma_f32_16x16x32_bf16 v[168:171], a[72:75], v[112:115], 0
    s_waitcnt lgkmcnt(3)
    ds_write_b128 v9, v[236:239] offset:16
    v_mul_f32 v186, v186, v190
    v_mul_f32 v187, v187, v191
    v_mfma_f32_16x16x32_bf16 v[172:175], a[84:87], v[24:27], 0
    s_waitcnt lgkmcnt(3)
    ds_read_b128 a[40:43], v10
    v_mul_f32 v176, v176, v180
    v_mul_f32 v177, v177, v181
    v_mfma_f32_16x16x32_bf16 v[168:171], a[88:91], v[116:119], v[168:171]
    ds_read_b128 a[44:47], v10 offset:1152
    v_mul_f32 v178, v178, v182
    v_mul_f32 v179, v179, v183
    v_mfma_f32_16x16x32_bf16 v[160:163], a[80:83], v[112:115], 0
    v_cvt_pk_bf16_f32 v224, v187, v179
    v_cvt_pk_bf16_f32 v226, v186, v178
    v_mfma_f32_16x16x32_bf16 v[164:167], a[84:87], v[60:63], 0
    s_waitcnt lgkmcnt(4)
    v_cvt_pk_bf16_f32 v228, v185, v177
    v_cvt_pk_bf16_f32 v230, v184, v176
    v_mfma_f32_16x16x32_bf16 v[160:163], a[92:95], v[116:119], v[160:163]
    v_mul_f32 v168, v168, v172
    v_mul_f32 v169, v169, v173
    v_mul_f32 v170, v170, v174
    v_mul_f32 v171, v171, v175
    s_waitcnt lgkmcnt(0)
    buffer_store_dwordx4 a[40:43], v8, s[24:27], s40 offen sc1
    s_add_u32 s40, s40, 0x40000
    buffer_store_dwordx4 a[44:47], v8, s[24:27], s41 offen sc1
    s_add_u32 s41, s41, 0x40000
    v_pk_mul_f32 v[160:161], v[160:161], v[164:165]
    v_pk_mul_f32 v[162:163], v[162:163], v[166:167]
    v_cvt_pk_bf16_f32 v225, v171, v163
    v_cvt_pk_bf16_f32 v227, v170, v162
    v_cvt_pk_bf16_f32 v229, v169, v161
    v_cvt_pk_bf16_f32 v231, v168, v160
    ds_write_b128 v9, v[224:227] offset:0
    ds_write_b128 v9, v[228:231] offset:16
    ds_read_b128 a[48:51], v10
    ds_read_b128 a[52:55], v10 offset:1152
    v_mov_b32 v31, s3
    s_waitcnt lgkmcnt(0)
    buffer_store_dwordx4 a[48:51], v8, s[24:27], s40 offen sc1
    s_add_u32 s40, s40, 0x40000
    buffer_store_dwordx4 a[52:55], v8, s[24:27], s41 offen sc1
    s_add_u32 s41, s41, 0x40000
    s_waitcnt vmcnt(0)
    s_mov_b32 exec_hi, 0xffffff
    buffer_atomic_swap v31, v45, s[24:27], s44 offen sc1
    s_mov_b32 exec_hi, -1
    s_or_b32 s62, s2, s4
    s_cmp_lg_u32 s62, 0
    s_cbranch_scc1 L_exit
    v_and_b32 v2, 31, v1
    v_lshlrev_b32 v2, 2, v2
    v_lshrrev_b32 v3, 5, v1
    v_lshl_add_u32 v4, v3, 13, v2
    v_add_u32 v24, 0xf00100, v4
    v_add_u32 v25, 0xf04100, v4
    v_min_u32 v2, 6, v7
    v_lshlrev_b32 v2, 2, v2
    v_lshl_add_u32 v2, v5, 10, v2
    v_add_u32 v8, 0xf00180, v2
    v_add_u32 v9, 0xf02180, v2
    v_add_u32 v10, 0xf04180, v2
    v_add_u32 v11, 0xf06180, v2
    v_add_u32 v12, 0xf08180, v2
    v_add_u32 v13, 0xf0a180, v2
    v_add_u32 v14, 0xf0c180, v2
    v_add_u32 v15, 0xf0e180, v2
    v_add_u32 v16, 0xf10180, v2
    v_add_u32 v17, 0xf12180, v2
    v_add_u32 v18, 0xf14180, v2
    v_add_u32 v19, 0xf16180, v2
    v_add_u32 v20, 0xf18180, v2
    v_add_u32 v21, 0xf1a180, v2
    v_add_u32 v22, 0xf1c180, v2
    v_add_u32 v23, 0xf1e180, v2
    s_mov_b32 s7, 0
    v_mov_b32 v3, 0xf001e0
    s_mov_b64 exec, 1
L_w0_71:
    s_sleep 12
    global_atomic_or v32, v3, v30, s[24:25] sc0 sc1
    s_add_u32 s7, s7, 1
    s_waitcnt vmcnt(0)
    v_cmp_ne_u32 vcc, s3, v32
    s_cmp_lt_u32 s7, 16384
    s_cselect_b64 vcc, vcc, 0
    s_cbranch_vccnz L_w0_71
    s_mov_b64 exec, -1
L_w0_72:
    global_atomic_or v32, v8, v30, s[24:25] sc0 sc1
    global_atomic_or v33, v9, v30, s[24:25] sc0 sc1
    global_atomic_or v34, v10, v30, s[24:25] sc0 sc1
    global_atomic_or v35, v11, v30, s[24:25] sc0 sc1
    global_atomic_or v36, v12, v30, s[24:25] sc0 sc1
    global_atomic_or v37, v13, v30, s[24:25] sc0 sc1
    global_atomic_or v38, v14, v30, s[24:25] sc0 sc1
    global_atomic_or v39, v15, v30, s[24:25] sc0 sc1
    global_atomic_or v40, v16, v30, s[24:25] sc0 sc1
    global_atomic_or v41, v17, v30, s[24:25] sc0 sc1
    global_atomic_or v42, v18, v30, s[24:25] sc0 sc1
    global_atomic_or v43, v19, v30, s[24:25] sc0 sc1
    global_atomic_or v44, v20, v30, s[24:25] sc0 sc1
    global_atomic_or v45, v21, v30, s[24:25] sc0 sc1
    global_atomic_or v46, v22, v30, s[24:25] sc0 sc1
    global_atomic_or v47, v23, v30, s[24:25] sc0 sc1
    global_atomic_or v48, v24, v30, s[24:25] sc0 sc1
    global_atomic_or v49, v25, v30, s[24:25] sc0 sc1
    s_add_u32 s7, s7, 1
    s_waitcnt vmcnt(0)
    v_xor_b32 v32, v32, v31
    v_xor_b32 v33, v33, v31
    v_xor_b32 v34, v34, v31
    v_xor_b32 v35, v35, v31
    v_xor_b32 v36, v36, v31
    v_xor_b32 v37, v37, v31
    v_xor_b32 v38, v38, v31
    v_xor_b32 v39, v39, v31
    v_xor_b32 v40, v40, v31
    v_xor_b32 v41, v41, v31
    v_xor_b32 v42, v42, v31
    v_xor_b32 v43, v43, v31
    v_xor_b32 v44, v44, v31
    v_xor_b32 v45, v45, v31
    v_xor_b32 v46, v46, v31
    v_xor_b32 v47, v47, v31
    v_xor_b32 v48, v48, v31
    v_xor_b32 v49, v49, v31
    v_or3_b32 v32, v32, v33, v34
    v_or3_b32 v32, v32, v35, v36
    v_or3_b32 v32, v32, v37, v38
    v_or3_b32 v32, v32, v39, v40
    v_or3_b32 v32, v32, v41, v42
    v_or3_b32 v32, v32, v43, v44
    v_or3_b32 v32, v32, v45, v46
    v_or3_b32 v32, v32, v47, v48
    v_or_b32 v32, v32, v49
    v_cmp_ne_u32 vcc, 0, v32
    s_cmp_lt_u32 s7, 16384
    s_cselect_b64 vcc, vcc, 0
    s_cbranch_vccz L_w0d_73
    s_sleep 8
    s_branch L_w0_72
L_w0d_73:
    s_mov_b64 exec, 1
    buffer_store_dword v31, v30, s[24:27], 0 offen offset:0 sc1
L_end:
    s_endpgm
.section .rodata,"a"
.p2align 6
.amdhsa_kernel gated_mix__ssm_conv_h3__dense_activation_gelu__prompt_kernel
  .amdhsa_next_free_vgpr 512
  .amdhsa_next_free_sgpr 102
  .amdhsa_accum_offset 256
  .amdhsa_group_segment_fixed_size 0
  .amdhsa_kernarg_size 120
  .amdhsa_user_sgpr_count 2
  .amdhsa_user_sgpr_kernarg_segment_ptr 1
  .amdhsa_system_sgpr_workgroup_id_x 1
.end_amdhsa_kernel
```
